```python
import torch

def _softmax(x, axis=-1):
    return torch.softmax(x, dim=axis)
def _gelu(x):
    return torch.nn.functional.gelu(x, approximate="tanh")
def _silu(x):
    return torch.nn.functional.silu(x)
def _sigmoid(x):
    return torch.sigmoid(x)
def _layernorm(x, axis=-1, eps=1e-5):
    m = x.mean(dim=axis, keepdim=True)
    v = x.var(dim=axis, keepdim=True, unbiased=False)
    return (x - m) / torch.sqrt(v + eps)
def _scatter_add(tgt, idx, src, axis=0):
    return tgt.clone().index_add_(axis, idx, src)
def _segment_sum(src, seg, n):
    out = torch.zeros((n,) + src.shape[1:], dtype=src.dtype)
    return out.index_add_(0, seg, src)
def _pad(x, pw):
    flat = tuple(v for pair in reversed(pw) for v in pair)
    return torch.nn.functional.pad(x, flat)

kernel_name = 'concat_heads__gqa_block_cached__gqa_block_cached__decode'

def setup_inputs():

    _w = (lambda a: (lambda t: t.to(torch.bfloat16) if t.is_floating_point() else t)(torch.as_tensor(a)))
    def _A_setup():
        B, Sq, D = 2, 1, 512
        Hq, Hkv, Sk, Dh = 32, 32, 8192, 128
        assert Hq % Hkv == 0, (Hq, Hkv)
        return {
            "x": _w((lambda *s: torch.randn(*s, dtype=torch.bfloat16) * 0.8)(B, Sq, D)),
            "k_cache": _w((lambda *s: torch.randn(*s, dtype=torch.bfloat16) * 0.8)(B, Hkv, Sk, Dh)),
            "v_cache": _w((lambda *s: torch.randn(*s, dtype=torch.bfloat16) * 0.05)(B, Hkv, Sk, Dh)),
            "wq": _w((lambda *s: torch.randn(*s, dtype=torch.bfloat16) * 0.8)(D, Hq * Dh) * (D ** -0.5)),
            "wo": _w((lambda *s: torch.randn(*s, dtype=torch.bfloat16) * 0.05)(Hq * Dh, D) * ((Hq * Dh) ** -0.5)),
        }
    _A_in = _A_setup()

    def _B_setup():
        B, Sq, D = 2, 1, 512
        Hq, Hkv, Sk, Dh = 32, 32, 8192, 128
        assert Hq % Hkv == 0, (Hq, Hkv)
        return {
            "x": _w((lambda *s: torch.randn(*s, dtype=torch.bfloat16) * 0.8)(B, Sq, D)),
            "k_cache": _w((lambda *s: torch.randn(*s, dtype=torch.bfloat16) * 0.8)(B, Hkv, Sk, Dh)),
            "v_cache": _w((lambda *s: torch.randn(*s, dtype=torch.bfloat16) * 0.05)(B, Hkv, Sk, Dh)),
            "wq": _w((lambda *s: torch.randn(*s, dtype=torch.bfloat16) * 0.8)(D, Hq * Dh) * (D ** -0.5)),
            "wo": _w((lambda *s: torch.randn(*s, dtype=torch.bfloat16) * 0.05)(Hq * Dh, D) * ((Hq * Dh) ** -0.5)),
        }
    _B_in = _B_setup()

    return {
        "A_x": _A_in["x"],
        "A_k_cache": _A_in["k_cache"],
        "A_v_cache": _A_in["v_cache"],
        "A_wq": _A_in["wq"],
        "A_wo": _A_in["wo"],
        "B_x": _B_in["x"],
        "B_k_cache": _B_in["k_cache"],
        "B_v_cache": _B_in["v_cache"],
        "B_wq": _B_in["wq"],
        "B_wo": _B_in["wo"],
    }

def reference(A_x, A_k_cache, A_v_cache, A_wq, A_wo, B_x, B_k_cache, B_v_cache, B_wq, B_wo):
    def _A_ref(x, k_cache, v_cache, wq, wo):
        B, Sq, D = x.shape
        Hq, Dh = 32, 128
        Hkv = k_cache.shape[1]
        rep = Hq // Hkv
        q = (lambda x, *d: x.permute(*d))((x @ wq).reshape(B, Sq, Hq, Dh), 0, 2, 1, 3)
        k = (lambda x, n, axis: torch.repeat_interleave(x, n, dim=axis))(k_cache, rep, axis=1)
        v = (lambda x, n, axis: torch.repeat_interleave(x, n, dim=axis))(v_cache, rep, axis=1)
        scores = torch.einsum("bhqd,bhkd->bhqk", q, k) * (Dh ** -0.5)
        p = _softmax(scores, axis=-1)
        o = torch.einsum("bhqk,bhkd->bhqd", p, v)
        return (lambda x, *d: x.permute(*d))(o, 0, 2, 1, 3).reshape(B, Sq, Hq * Dh) @ wo

    def _B_ref(x, k_cache, v_cache, wq, wo):
        B, Sq, D = x.shape
        Hq, Dh = 32, 128
        Hkv = k_cache.shape[1]
        rep = Hq // Hkv
        q = (lambda x, *d: x.permute(*d))((x @ wq).reshape(B, Sq, Hq, Dh), 0, 2, 1, 3)
        k = (lambda x, n, axis: torch.repeat_interleave(x, n, dim=axis))(k_cache, rep, axis=1)
        v = (lambda x, n, axis: torch.repeat_interleave(x, n, dim=axis))(v_cache, rep, axis=1)
        scores = torch.einsum("bhqd,bhkd->bhqk", q, k) * (Dh ** -0.5)
        p = _softmax(scores, axis=-1)
        o = torch.einsum("bhqk,bhkd->bhqd", p, v)
        return (lambda x, *d: x.permute(*d))(o, 0, 2, 1, 3).reshape(B, Sq, Hq * Dh) @ wo

    a = _A_ref(A_x, A_k_cache, A_v_cache, A_wq, A_wo)
    b = _B_ref(B_x, B_k_cache, B_v_cache, B_wq, B_wo)
    return torch.concatenate([a, b], axis=-1)
```

```asm
; @launch grid=(256,1,1) block=(512,1,1) lds=29696
.amdgcn_target "amdgcn-amd-amdhsa--gfx950"
.text
.globl concat_heads__gqa_block_cached__gqa_block_cached__decode_kernel
.p2align 8
.type concat_heads__gqa_block_cached__gqa_block_cached__decode_kernel,@function
concat_heads__gqa_block_cached__gqa_block_cached__decode_kernel:
s_cmp_ge_u32 s2, 256
s_cbranch_scc1 L_end
s_lshr_b32 s61, s2, 3
s_lshr_b32 s50, s2, 7
s_mul_i32 s47, s50, 40
s_add_u32 s62, s0, s47
s_addc_u32 s63, s1, 0
s_load_dwordx8 s[4:11], s[62:63], 0
s_load_dwordx2 s[12:13], s[62:63], 32
s_load_dwordx4 s[16:19], s[0:1], 80
s_load_dwordx2 s[20:21], s[0:1], 96
v_lshrrev_b32 v4, 6, v0
v_and_b32 v1, 63, v0
v_readfirstlane_b32 s49, v4
s_and_b32 s47, s2, 7
s_lshl_b32 s47, s47, 2
s_bfe_u32 s64, s61, 0x20002
s_add_u32 s51, s47, s64
s_and_b32 s92, s61, 3
s_lshr_b32 s52, s92, 1
s_and_b32 s53, s92, 1
v_and_b32 v2, 15, v0
v_bfe_u32 v3, v0, 4, 2
s_cmp_ge_u32 s49, 4
s_cbranch_scc1 L_helper
v_lshlrev_b32 v5, 12, v4
v_lshl_add_u32 v5, v1, 4, v5
s_lshl_b32 s47, s52, 5
s_add_u32 s47, s47, s51
s_lshl_b32 s47, s47, 1
s_add_u32 s47, s47, s53
s_lshl_b32 s47, s47, 20
s_mov_b32 s26, 0x100000
s_mov_b32 s27, 0x20000
s_mov_b32 s46, 0
s_and_b32 s22, s2, 3
s_lshl_b32 s22, s22, 1
s_bfe_u32 s64, s2, 0x10006
s_add_u32 s22, s22, s64
s_lshl_b32 s22, s22, 17
s_mov_b32 s23, s22
s_waitcnt lgkmcnt(0)
s_add_u32 s24, s6, s47
s_addc_u32 s25, s7, 0
buffer_load_dwordx4 v[128:131], v5, s[24:27], s23 offen offset:0 nt
buffer_load_dwordx4 v[132:135], v5, s[24:27], s23 offen offset:1024 nt
buffer_load_dwordx4 v[136:139], v5, s[24:27], s23 offen offset:2048 nt
buffer_load_dwordx4 v[140:143], v5, s[24:27], s23 offen offset:3072 nt
s_add_u32 s46, s46, 16384
s_add_u32 s23, s46, s22
s_and_b32 s23, s23, 0xfffff
s_and_b32 s64, s46, 0x300000
s_or_b32 s23, s23, s64
buffer_load_dwordx4 v[144:147], v5, s[24:27], s23 offen offset:0 nt
s_add_u32 s44, s8, s47
s_addc_u32 s45, s9, 0
s_sub_u32 s44, s44, 0x100000
s_subb_u32 s45, s45, 0
v_and_b32 v29, 1, v2
v_lshlrev_b32 v29, 4, v29
v_mov_b32 v30, 0xffff
v_lshlrev_b32 v30, v29, v30
v_and_b32 v29, 15, v2
v_lshrrev_b32 v29, 1, v29
v_cmp_eq_u32 s[68:69], 0, v29
v_cmp_eq_u32 s[70:71], 1, v29
v_cmp_eq_u32 s[72:73], 2, v29
v_cmp_eq_u32 s[74:75], 3, v29
s_nop 1
v_cndmask_b32 v8, 0, v30, s[68:69]
v_cndmask_b32 v9, 0, v30, s[70:71]
v_cndmask_b32 v10, 0, v30, s[72:73]
v_cndmask_b32 v11, 0, v30, s[74:75]
s_mov_b32 s60, 0x3e0293ee
s_mov_b32 s56, 0xcccccccc
s_mov_b32 s57, 0xcccccccc
s_mov_b32 s58, 0xaaaaaaaa
s_mov_b32 s59, 0xaaaaaaaa
v_lshlrev_b32 v6, 12, v4
v_lshl_add_u32 v6, v1, 4, v6
v_lshlrev_b32 v7, 5, v2
v_lshl_add_u32 v7, v3, 4, v7
v_mov_b32 v44, 0
v_mov_b32 v45, 0
v_mov_b32 v46, 0
v_mov_b32 v47, 0
s_waitcnt vmcnt(4)
buffer_load_dwordx4 v[148:151], v5, s[24:27], s23 offen offset:1024 nt
s_waitcnt vmcnt(4)
buffer_load_dwordx4 v[152:155], v5, s[24:27], s23 offen offset:2048 nt
s_waitcnt vmcnt(4)
buffer_load_dwordx4 v[156:159], v5, s[24:27], s23 offen offset:3072 nt
s_waitcnt vmcnt(4)
s_add_u32 s46, s46, 16384
s_add_u32 s23, s46, s22
s_and_b32 s23, s23, 0xfffff
s_and_b32 s64, s46, 0x300000
s_or_b32 s23, s23, s64
buffer_load_dwordx4 v[160:163], v5, s[24:27], s23 offen offset:0 nt
s_waitcnt vmcnt(4)
buffer_load_dwordx4 v[164:167], v5, s[24:27], s23 offen offset:1024 nt
s_waitcnt vmcnt(4)
buffer_load_dwordx4 v[168:171], v5, s[24:27], s23 offen offset:2048 nt
s_waitcnt vmcnt(4)
buffer_load_dwordx4 v[172:175], v5, s[24:27], s23 offen offset:3072 nt
s_waitcnt vmcnt(4)
s_add_u32 s46, s46, 16384
s_add_u32 s23, s46, s22
s_and_b32 s23, s23, 0xfffff
s_and_b32 s64, s46, 0x300000
s_or_b32 s23, s23, s64
buffer_load_dwordx4 v[176:179], v5, s[24:27], s23 offen offset:0 nt
s_waitcnt vmcnt(4)
buffer_load_dwordx4 v[180:183], v5, s[24:27], s23 offen offset:1024 nt
s_waitcnt vmcnt(4)
buffer_load_dwordx4 v[184:187], v5, s[24:27], s23 offen offset:2048 nt
s_waitcnt vmcnt(4)
buffer_load_dwordx4 v[188:191], v5, s[24:27], s23 offen offset:3072 nt
s_waitcnt vmcnt(4)
s_add_u32 s46, s46, 16384
s_add_u32 s23, s46, s22
s_and_b32 s23, s23, 0xfffff
s_and_b32 s64, s46, 0x300000
s_or_b32 s23, s23, s64
buffer_load_dwordx4 v[192:195], v5, s[24:27], s23 offen offset:0 nt
s_waitcnt vmcnt(4)
buffer_load_dwordx4 v[196:199], v5, s[24:27], s23 offen offset:1024 nt
s_waitcnt vmcnt(4)
buffer_load_dwordx4 v[200:203], v5, s[24:27], s23 offen offset:2048 nt
s_waitcnt vmcnt(4)
buffer_load_dwordx4 v[204:207], v5, s[24:27], s23 offen offset:3072 nt
s_waitcnt vmcnt(4)
s_add_u32 s46, s46, 16384
s_add_u32 s23, s46, s22
s_and_b32 s23, s23, 0xfffff
s_and_b32 s64, s46, 0x300000
s_or_b32 s23, s23, s64
buffer_load_dwordx4 v[208:211], v5, s[24:27], s23 offen offset:0 nt
s_waitcnt vmcnt(4)
buffer_load_dwordx4 v[212:215], v5, s[24:27], s23 offen offset:1024 nt
s_waitcnt vmcnt(4)
buffer_load_dwordx4 v[216:219], v5, s[24:27], s23 offen offset:2048 nt
s_waitcnt vmcnt(4)
buffer_load_dwordx4 v[220:223], v5, s[24:27], s23 offen offset:3072 nt
s_waitcnt vmcnt(4)
s_add_u32 s46, s46, 16384
s_add_u32 s23, s46, s22
s_and_b32 s23, s23, 0xfffff
s_and_b32 s64, s46, 0x300000
s_or_b32 s23, s23, s64
buffer_load_dwordx4 v[224:227], v5, s[24:27], s23 offen offset:0 nt
s_waitcnt vmcnt(4)
buffer_load_dwordx4 v[228:231], v5, s[24:27], s23 offen offset:1024 nt
s_waitcnt vmcnt(4)
buffer_load_dwordx4 v[232:235], v5, s[24:27], s23 offen offset:2048 nt
s_waitcnt vmcnt(4)
buffer_load_dwordx4 v[236:239], v5, s[24:27], s23 offen offset:3072 nt
s_waitcnt vmcnt(4)
s_add_u32 s46, s46, 16384
s_add_u32 s23, s46, s22
s_and_b32 s23, s23, 0xfffff
s_and_b32 s64, s46, 0x300000
s_or_b32 s23, s23, s64
buffer_load_dwordx4 v[240:243], v5, s[24:27], s23 offen offset:0 nt
s_waitcnt vmcnt(4)
buffer_load_dwordx4 v[244:247], v5, s[24:27], s23 offen offset:1024 nt
s_waitcnt vmcnt(4)
buffer_load_dwordx4 v[248:251], v5, s[24:27], s23 offen offset:2048 nt
s_waitcnt vmcnt(4)
buffer_load_dwordx4 v[252:255], v5, s[24:27], s23 offen offset:3072 nt
s_barrier
v_lshlrev_b32 v29, 5, v2
ds_read_b128 v[48:51], v29 offset:16384
ds_read_b128 v[52:55], v29 offset:16400
ds_read_b128 v[56:59], v29 offset:16896
ds_read_b128 v[60:63], v29 offset:16912
ds_read_b128 v[16:19], v29 offset:17408
ds_read_b128 v[20:23], v29 offset:17424
ds_read_b128 v[36:39], v29 offset:17920
ds_read_b128 v[40:43], v29 offset:17936
s_add_u32 s46, s46, 16384
s_add_u32 s23, s46, s22
s_and_b32 s23, s23, 0xfffff
s_and_b32 s64, s46, 0x300000
s_or_b32 s23, s23, s64
buffer_load_dwordx4 v[64:67], v5, s[24:27], s23 offen offset:0 nt
buffer_load_dwordx4 v[68:71], v5, s[24:27], s23 offen offset:1024 nt
buffer_load_dwordx4 v[72:75], v5, s[24:27], s23 offen offset:2048 nt
buffer_load_dwordx4 v[76:79], v5, s[24:27], s23 offen offset:3072 nt
s_add_u32 s46, s46, 16384
s_add_u32 s23, s46, s22
s_and_b32 s23, s23, 0xfffff
s_and_b32 s64, s46, 0x300000
s_or_b32 s23, s23, s64
buffer_load_dwordx4 v[80:83], v5, s[24:27], s23 offen offset:0 nt
s_waitcnt lgkmcnt(0)
v_add_f32 v48, v48, v56
v_add_f32 v16, v16, v36
v_add_f32 v49, v49, v57
v_add_f32 v17, v17, v37
v_add_f32 v50, v50, v58
v_add_f32 v18, v18, v38
v_add_f32 v51, v51, v59
v_add_f32 v19, v19, v39
v_add_f32 v52, v52, v60
v_add_f32 v20, v20, v40
v_add_f32 v53, v53, v61
v_add_f32 v21, v21, v41
v_add_f32 v54, v54, v62
v_add_f32 v22, v22, v42
v_add_f32 v55, v55, v63
v_add_f32 v23, v23, v43
v_add_f32 v48, v48, v16
v_add_f32 v49, v49, v17
v_add_f32 v50, v50, v18
v_add_f32 v51, v51, v19
v_add_f32 v52, v52, v20
v_add_f32 v53, v53, v21
v_add_f32 v54, v54, v22
v_add_f32 v55, v55, v23
v_cvt_pk_bf16_f32 v12, v48, v49
v_cvt_pk_bf16_f32 v13, v50, v51
v_cvt_pk_bf16_f32 v14, v52, v53
v_cvt_pk_bf16_f32 v15, v54, v55
v_mov_b32 v48, v6
s_mov_b32 s48, 0
s_waitcnt vmcnt(36)
v_dot2_f32_bf16 v16, v128, v12, 0
v_dot2_f32_bf16 v16, v129, v13, v16
v_dot2_f32_bf16 v16, v130, v14, v16
v_dot2_f32_bf16 v16, v131, v15, v16
s_waitcnt vmcnt(35)
v_dot2_f32_bf16 v17, v132, v12, 0
v_dot2_f32_bf16 v17, v133, v13, v17
v_dot2_f32_bf16 v17, v134, v14, v17
v_dot2_f32_bf16 v17, v135, v15, v17
s_waitcnt vmcnt(34)
v_dot2_f32_bf16 v18, v136, v12, 0
v_dot2_f32_bf16 v18, v137, v13, v18
v_dot2_f32_bf16 v18, v138, v14, v18
v_dot2_f32_bf16 v18, v139, v15, v18
v_add_f32_dpp v20, v16, v16 row_ror:8 row_mask:0xf bank_mask:0x3
v_add_f32_dpp v20, v17, v17 row_ror:8 row_mask:0xf bank_mask:0xc
s_waitcnt vmcnt(33)
v_dot2_f32_bf16 v19, v140, v12, 0
v_dot2_f32_bf16 v19, v141, v13, v19
v_dot2_f32_bf16 v19, v142, v14, v19
v_dot2_f32_bf16 v19, v143, v15, v19
s_waitcnt vmcnt(32)
v_dot2_f32_bf16 v16, v144, v12, 0
v_dot2_f32_bf16 v16, v145, v13, v16
v_dot2_f32_bf16 v16, v146, v14, v16
v_dot2_f32_bf16 v16, v147, v15, v16
v_add_f32_dpp v21, v18, v18 row_ror:8 row_mask:0xf bank_mask:0x3
v_add_f32_dpp v21, v19, v19 row_ror:8 row_mask:0xf bank_mask:0xc
s_waitcnt vmcnt(31)
v_dot2_f32_bf16 v17, v148, v12, 0
v_dot2_f32_bf16 v17, v149, v13, v17
v_dot2_f32_bf16 v17, v150, v14, v17
v_dot2_f32_bf16 v17, v151, v15, v17
v_add_f32_dpp v22, v20, v20 row_shl:4 row_mask:0xf bank_mask:0x5
v_add_f32_dpp v22, v21, v21 row_shr:4 row_mask:0xf bank_mask:0xa
s_waitcnt vmcnt(30)
v_dot2_f32_bf16 v18, v152, v12, 0
v_dot2_f32_bf16 v18, v153, v13, v18
v_dot2_f32_bf16 v18, v154, v14, v18
v_dot2_f32_bf16 v18, v155, v15, v18
v_add_f32_dpp v20, v16, v16 row_ror:8 row_mask:0xf bank_mask:0x3
v_add_f32_dpp v20, v17, v17 row_ror:8 row_mask:0xf bank_mask:0xc
s_waitcnt vmcnt(29)
v_dot2_f32_bf16 v19, v156, v12, 0
v_dot2_f32_bf16 v19, v157, v13, v19
v_dot2_f32_bf16 v19, v158, v14, v19
v_dot2_f32_bf16 v19, v159, v15, v19
s_waitcnt vmcnt(28)
v_dot2_f32_bf16 v16, v160, v12, 0
v_dot2_f32_bf16 v16, v161, v13, v16
v_dot2_f32_bf16 v16, v162, v14, v16
v_dot2_f32_bf16 v16, v163, v15, v16
v_add_f32_dpp v21, v18, v18 row_ror:8 row_mask:0xf bank_mask:0x3
v_add_f32_dpp v21, v19, v19 row_ror:8 row_mask:0xf bank_mask:0xc
s_waitcnt vmcnt(27)
v_dot2_f32_bf16 v17, v164, v12, 0
v_dot2_f32_bf16 v17, v165, v13, v17
v_dot2_f32_bf16 v17, v166, v14, v17
v_dot2_f32_bf16 v17, v167, v15, v17
v_add_f32_dpp v23, v20, v20 row_shl:4 row_mask:0xf bank_mask:0x5
v_add_f32_dpp v23, v21, v21 row_shr:4 row_mask:0xf bank_mask:0xa
s_waitcnt vmcnt(26)
v_dot2_f32_bf16 v18, v168, v12, 0
v_dot2_f32_bf16 v18, v169, v13, v18
v_dot2_f32_bf16 v18, v170, v14, v18
v_dot2_f32_bf16 v18, v171, v15, v18
v_add_f32_dpp v20, v16, v16 row_ror:8 row_mask:0xf bank_mask:0x3
v_add_f32_dpp v20, v17, v17 row_ror:8 row_mask:0xf bank_mask:0xc
s_waitcnt vmcnt(25)
v_dot2_f32_bf16 v19, v172, v12, 0
v_dot2_f32_bf16 v19, v173, v13, v19
v_dot2_f32_bf16 v19, v174, v14, v19
v_dot2_f32_bf16 v19, v175, v15, v19
v_cndmask_b32 v29, v22, v23, s[56:57]
v_cndmask_b32 v30, v23, v22, s[56:57]
s_nop 1
v_add_f32_dpp v26, v30, v29 quad_perm:[2,3,0,1] row_mask:0xf bank_mask:0xf
s_waitcnt vmcnt(24)
v_dot2_f32_bf16 v16, v176, v12, 0
v_dot2_f32_bf16 v16, v177, v13, v16
v_dot2_f32_bf16 v16, v178, v14, v16
v_dot2_f32_bf16 v16, v179, v15, v16
v_add_f32_dpp v21, v18, v18 row_ror:8 row_mask:0xf bank_mask:0x3
v_add_f32_dpp v21, v19, v19 row_ror:8 row_mask:0xf bank_mask:0xc
s_waitcnt vmcnt(23)
v_dot2_f32_bf16 v17, v180, v12, 0
v_dot2_f32_bf16 v17, v181, v13, v17
v_dot2_f32_bf16 v17, v182, v14, v17
v_dot2_f32_bf16 v17, v183, v15, v17
v_add_f32_dpp v24, v20, v20 row_shl:4 row_mask:0xf bank_mask:0x5
v_add_f32_dpp v24, v21, v21 row_shr:4 row_mask:0xf bank_mask:0xa
s_waitcnt vmcnt(22)
v_dot2_f32_bf16 v18, v184, v12, 0
v_dot2_f32_bf16 v18, v185, v13, v18
v_dot2_f32_bf16 v18, v186, v14, v18
v_dot2_f32_bf16 v18, v187, v15, v18
v_add_f32_dpp v20, v16, v16 row_ror:8 row_mask:0xf bank_mask:0x3
v_add_f32_dpp v20, v17, v17 row_ror:8 row_mask:0xf bank_mask:0xc
s_waitcnt vmcnt(21)
v_dot2_f32_bf16 v19, v188, v12, 0
v_dot2_f32_bf16 v19, v189, v13, v19
v_dot2_f32_bf16 v19, v190, v14, v19
v_dot2_f32_bf16 v19, v191, v15, v19
s_nop 2
v_add_f32_dpp v21, v18, v18 row_ror:8 row_mask:0xf bank_mask:0x3
v_add_f32_dpp v21, v19, v19 row_ror:8 row_mask:0xf bank_mask:0xc
s_nop 1
v_add_f32_dpp v25, v20, v20 row_shl:4 row_mask:0xf bank_mask:0x5
v_add_f32_dpp v25, v21, v21 row_shr:4 row_mask:0xf bank_mask:0xa
v_cndmask_b32 v29, v24, v25, s[56:57]
v_cndmask_b32 v30, v25, v24, s[56:57]
s_nop 1
v_add_f32_dpp v27, v30, v29 quad_perm:[2,3,0,1] row_mask:0xf bank_mask:0xf
v_cndmask_b32 v29, v26, v27, s[58:59]
v_cndmask_b32 v30, v27, v26, s[58:59]
s_nop 1
v_add_f32_dpp v28, v30, v29 quad_perm:[1,0,3,2] row_mask:0xf bank_mask:0xf
ds_write_b32 v48, v28
s_add_u32 s48, s48, 1
s_and_b32 s47, s48, 3
s_cmp_eq_u32 s47, 0
s_cselect_b32 s47, 1012, 4
v_add_u32 v48, s47, v48
s_waitcnt vmcnt(20)
v_dot2_f32_bf16 v16, v192, v12, 0
v_dot2_f32_bf16 v16, v193, v13, v16
v_dot2_f32_bf16 v16, v194, v14, v16
v_dot2_f32_bf16 v16, v195, v15, v16
s_waitcnt vmcnt(19)
v_dot2_f32_bf16 v17, v196, v12, 0
v_dot2_f32_bf16 v17, v197, v13, v17
v_dot2_f32_bf16 v17, v198, v14, v17
v_dot2_f32_bf16 v17, v199, v15, v17
s_waitcnt vmcnt(18)
v_dot2_f32_bf16 v18, v200, v12, 0
v_dot2_f32_bf16 v18, v201, v13, v18
v_dot2_f32_bf16 v18, v202, v14, v18
v_dot2_f32_bf16 v18, v203, v15, v18
v_add_f32_dpp v20, v16, v16 row_ror:8 row_mask:0xf bank_mask:0x3
v_add_f32_dpp v20, v17, v17 row_ror:8 row_mask:0xf bank_mask:0xc
s_waitcnt vmcnt(17)
v_dot2_f32_bf16 v19, v204, v12, 0
v_dot2_f32_bf16 v19, v205, v13, v19
v_dot2_f32_bf16 v19, v206, v14, v19
v_dot2_f32_bf16 v19, v207, v15, v19
s_waitcnt vmcnt(16)
v_dot2_f32_bf16 v16, v208, v12, 0
v_dot2_f32_bf16 v16, v209, v13, v16
v_dot2_f32_bf16 v16, v210, v14, v16
v_dot2_f32_bf16 v16, v211, v15, v16
v_add_f32_dpp v21, v18, v18 row_ror:8 row_mask:0xf bank_mask:0x3
v_add_f32_dpp v21, v19, v19 row_ror:8 row_mask:0xf bank_mask:0xc
s_waitcnt vmcnt(15)
v_dot2_f32_bf16 v17, v212, v12, 0
v_dot2_f32_bf16 v17, v213, v13, v17
v_dot2_f32_bf16 v17, v214, v14, v17
v_dot2_f32_bf16 v17, v215, v15, v17
v_add_f32_dpp v22, v20, v20 row_shl:4 row_mask:0xf bank_mask:0x5
v_add_f32_dpp v22, v21, v21 row_shr:4 row_mask:0xf bank_mask:0xa
s_waitcnt vmcnt(14)
v_dot2_f32_bf16 v18, v216, v12, 0
v_dot2_f32_bf16 v18, v217, v13, v18
v_dot2_f32_bf16 v18, v218, v14, v18
v_dot2_f32_bf16 v18, v219, v15, v18
v_add_f32_dpp v20, v16, v16 row_ror:8 row_mask:0xf bank_mask:0x3
v_add_f32_dpp v20, v17, v17 row_ror:8 row_mask:0xf bank_mask:0xc
s_waitcnt vmcnt(13)
v_dot2_f32_bf16 v19, v220, v12, 0
v_dot2_f32_bf16 v19, v221, v13, v19
v_dot2_f32_bf16 v19, v222, v14, v19
v_dot2_f32_bf16 v19, v223, v15, v19
s_waitcnt vmcnt(12)
v_dot2_f32_bf16 v16, v224, v12, 0
v_dot2_f32_bf16 v16, v225, v13, v16
v_dot2_f32_bf16 v16, v226, v14, v16
v_dot2_f32_bf16 v16, v227, v15, v16
v_add_f32_dpp v21, v18, v18 row_ror:8 row_mask:0xf bank_mask:0x3
v_add_f32_dpp v21, v19, v19 row_ror:8 row_mask:0xf bank_mask:0xc
s_waitcnt vmcnt(11)
v_dot2_f32_bf16 v17, v228, v12, 0
v_dot2_f32_bf16 v17, v229, v13, v17
v_dot2_f32_bf16 v17, v230, v14, v17
v_dot2_f32_bf16 v17, v231, v15, v17
v_add_f32_dpp v23, v20, v20 row_shl:4 row_mask:0xf bank_mask:0x5
v_add_f32_dpp v23, v21, v21 row_shr:4 row_mask:0xf bank_mask:0xa
s_waitcnt vmcnt(10)
v_dot2_f32_bf16 v18, v232, v12, 0
v_dot2_f32_bf16 v18, v233, v13, v18
v_dot2_f32_bf16 v18, v234, v14, v18
v_dot2_f32_bf16 v18, v235, v15, v18
v_add_f32_dpp v20, v16, v16 row_ror:8 row_mask:0xf bank_mask:0x3
v_add_f32_dpp v20, v17, v17 row_ror:8 row_mask:0xf bank_mask:0xc
s_waitcnt vmcnt(9)
v_dot2_f32_bf16 v19, v236, v12, 0
v_dot2_f32_bf16 v19, v237, v13, v19
v_dot2_f32_bf16 v19, v238, v14, v19
v_dot2_f32_bf16 v19, v239, v15, v19
v_cndmask_b32 v29, v22, v23, s[56:57]
v_cndmask_b32 v30, v23, v22, s[56:57]
s_nop 1
v_add_f32_dpp v26, v30, v29 quad_perm:[2,3,0,1] row_mask:0xf bank_mask:0xf
s_waitcnt vmcnt(8)
v_dot2_f32_bf16 v16, v240, v12, 0
v_dot2_f32_bf16 v16, v241, v13, v16
v_dot2_f32_bf16 v16, v242, v14, v16
v_dot2_f32_bf16 v16, v243, v15, v16
v_add_f32_dpp v21, v18, v18 row_ror:8 row_mask:0xf bank_mask:0x3
v_add_f32_dpp v21, v19, v19 row_ror:8 row_mask:0xf bank_mask:0xc
s_waitcnt vmcnt(7)
v_dot2_f32_bf16 v17, v244, v12, 0
v_dot2_f32_bf16 v17, v245, v13, v17
v_dot2_f32_bf16 v17, v246, v14, v17
v_dot2_f32_bf16 v17, v247, v15, v17
v_add_f32_dpp v24, v20, v20 row_shl:4 row_mask:0xf bank_mask:0x5
v_add_f32_dpp v24, v21, v21 row_shr:4 row_mask:0xf bank_mask:0xa
s_waitcnt vmcnt(6)
v_dot2_f32_bf16 v18, v248, v12, 0
v_dot2_f32_bf16 v18, v249, v13, v18
v_dot2_f32_bf16 v18, v250, v14, v18
v_dot2_f32_bf16 v18, v251, v15, v18
v_add_f32_dpp v20, v16, v16 row_ror:8 row_mask:0xf bank_mask:0x3
v_add_f32_dpp v20, v17, v17 row_ror:8 row_mask:0xf bank_mask:0xc
s_waitcnt vmcnt(5)
v_dot2_f32_bf16 v19, v252, v12, 0
v_dot2_f32_bf16 v19, v253, v13, v19
v_dot2_f32_bf16 v19, v254, v14, v19
v_dot2_f32_bf16 v19, v255, v15, v19
s_nop 2
v_add_f32_dpp v21, v18, v18 row_ror:8 row_mask:0xf bank_mask:0x3
v_add_f32_dpp v21, v19, v19 row_ror:8 row_mask:0xf bank_mask:0xc
s_nop 1
v_add_f32_dpp v25, v20, v20 row_shl:4 row_mask:0xf bank_mask:0x5
v_add_f32_dpp v25, v21, v21 row_shr:4 row_mask:0xf bank_mask:0xa
v_cndmask_b32 v29, v24, v25, s[56:57]
v_cndmask_b32 v30, v25, v24, s[56:57]
s_nop 1
v_add_f32_dpp v27, v30, v29 quad_perm:[2,3,0,1] row_mask:0xf bank_mask:0xf
v_cndmask_b32 v29, v26, v27, s[58:59]
v_cndmask_b32 v30, v27, v26, s[58:59]
s_nop 1
v_add_f32_dpp v28, v30, v29 quad_perm:[1,0,3,2] row_mask:0xf bank_mask:0xf
ds_write_b32 v48, v28
s_add_u32 s48, s48, 1
s_and_b32 s47, s48, 3
s_cmp_eq_u32 s47, 0
s_cselect_b32 s47, 1012, 4
v_add_u32 v48, s47, v48
s_and_b32 s47, s51, 3
s_cmp_eq_u32 s47, 1
s_cselect_b32 s72, 10, 0
s_getreg_b32 s47, hwreg(HW_REG_XCC_ID)
s_and_b32 s47, s47, 1
s_cmp_eq_u32 s47, 0
s_cselect_b32 s47, 4, 0
s_add_u32 s72, s72, s47
s_add_u32 s72, s72, s48
L_kdisp:
s_cmp_lt_u32 s48, s72
s_cbranch_scc1 L_kloopB
L_kloop:
s_waitcnt vmcnt(4)
buffer_load_dwordx4 v[84:87], v5, s[24:27], s23 offen offset:1024 nt
v_dot2_f32_bf16 v16, v64, v12, 0
v_dot2_f32_bf16 v16, v65, v13, v16
v_dot2_f32_bf16 v16, v66, v14, v16
v_dot2_f32_bf16 v16, v67, v15, v16
s_waitcnt vmcnt(4)
buffer_load_dwordx4 v[88:91], v5, s[24:27], s23 offen offset:2048 nt
v_dot2_f32_bf16 v17, v68, v12, 0
v_dot2_f32_bf16 v17, v69, v13, v17
v_dot2_f32_bf16 v17, v70, v14, v17
v_dot2_f32_bf16 v17, v71, v15, v17
s_waitcnt vmcnt(4)
buffer_load_dwordx4 v[92:95], v5, s[24:27], s23 offen offset:3072 nt
v_dot2_f32_bf16 v18, v72, v12, 0
v_dot2_f32_bf16 v18, v73, v13, v18
v_dot2_f32_bf16 v18, v74, v14, v18
v_dot2_f32_bf16 v18, v75, v15, v18
v_add_f32_dpp v20, v16, v16 row_ror:8 row_mask:0xf bank_mask:0x3
v_add_f32_dpp v20, v17, v17 row_ror:8 row_mask:0xf bank_mask:0xc
s_waitcnt vmcnt(4)
s_add_u32 s46, s46, 16384
s_cmp_eq_u32 s46, 0x100000
s_cselect_b32 s24, s44, s24
s_cselect_b32 s25, s45, s25
s_cselect_b32 s26, 0x200000, s26
s_add_u32 s23, s46, s22
s_and_b32 s23, s23, 0xfffff
s_and_b32 s64, s46, 0x300000
s_or_b32 s23, s23, s64
buffer_load_dwordx4 v[96:99], v5, s[24:27], s23 offen offset:0 nt
v_dot2_f32_bf16 v19, v76, v12, 0
v_dot2_f32_bf16 v19, v77, v13, v19
v_dot2_f32_bf16 v19, v78, v14, v19
v_dot2_f32_bf16 v19, v79, v15, v19
s_waitcnt vmcnt(4)
buffer_load_dwordx4 v[100:103], v5, s[24:27], s23 offen offset:1024 nt
v_dot2_f32_bf16 v16, v80, v12, 0
v_dot2_f32_bf16 v16, v81, v13, v16
v_dot2_f32_bf16 v16, v82, v14, v16
v_dot2_f32_bf16 v16, v83, v15, v16
v_add_f32_dpp v21, v18, v18 row_ror:8 row_mask:0xf bank_mask:0x3
v_add_f32_dpp v21, v19, v19 row_ror:8 row_mask:0xf bank_mask:0xc
s_waitcnt vmcnt(4)
buffer_load_dwordx4 v[104:107], v5, s[24:27], s23 offen offset:2048 nt
v_dot2_f32_bf16 v17, v84, v12, 0
v_dot2_f32_bf16 v17, v85, v13, v17
v_dot2_f32_bf16 v17, v86, v14, v17
v_dot2_f32_bf16 v17, v87, v15, v17
v_add_f32_dpp v22, v20, v20 row_shl:4 row_mask:0xf bank_mask:0x5
v_add_f32_dpp v22, v21, v21 row_shr:4 row_mask:0xf bank_mask:0xa
s_waitcnt vmcnt(4)
v_dot2_f32_bf16 v18, v88, v12, 0
v_dot2_f32_bf16 v18, v89, v13, v18
v_dot2_f32_bf16 v18, v90, v14, v18
v_dot2_f32_bf16 v18, v91, v15, v18
v_add_f32_dpp v20, v16, v16 row_ror:8 row_mask:0xf bank_mask:0x3
v_add_f32_dpp v20, v17, v17 row_ror:8 row_mask:0xf bank_mask:0xc
s_waitcnt vmcnt(3)
buffer_load_dwordx4 v[108:111], v5, s[24:27], s23 offen offset:3072 nt
s_add_u32 s46, s46, 16384
s_cmp_eq_u32 s46, 0x100000
s_cselect_b32 s24, s44, s24
s_cselect_b32 s25, s45, s25
s_cselect_b32 s26, 0x200000, s26
s_add_u32 s23, s46, s22
s_and_b32 s23, s23, 0xfffff
s_and_b32 s64, s46, 0x300000
s_or_b32 s23, s23, s64
buffer_load_dwordx4 v[112:115], v5, s[24:27], s23 offen offset:0 nt
v_dot2_f32_bf16 v19, v92, v12, 0
v_dot2_f32_bf16 v19, v93, v13, v19
v_dot2_f32_bf16 v19, v94, v14, v19
v_dot2_f32_bf16 v19, v95, v15, v19
s_waitcnt vmcnt(4)
buffer_load_dwordx4 v[116:119], v5, s[24:27], s23 offen offset:1024 nt
v_dot2_f32_bf16 v16, v96, v12, 0
v_dot2_f32_bf16 v16, v97, v13, v16
v_dot2_f32_bf16 v16, v98, v14, v16
v_dot2_f32_bf16 v16, v99, v15, v16
v_add_f32_dpp v21, v18, v18 row_ror:8 row_mask:0xf bank_mask:0x3
v_add_f32_dpp v21, v19, v19 row_ror:8 row_mask:0xf bank_mask:0xc
s_waitcnt vmcnt(4)
buffer_load_dwordx4 v[120:123], v5, s[24:27], s23 offen offset:2048 nt
v_dot2_f32_bf16 v17, v100, v12, 0
v_dot2_f32_bf16 v17, v101, v13, v17
v_dot2_f32_bf16 v17, v102, v14, v17
v_dot2_f32_bf16 v17, v103, v15, v17
v_add_f32_dpp v23, v20, v20 row_shl:4 row_mask:0xf bank_mask:0x5
v_add_f32_dpp v23, v21, v21 row_shr:4 row_mask:0xf bank_mask:0xa
s_waitcnt vmcnt(4)
buffer_load_dwordx4 v[124:127], v5, s[24:27], s23 offen offset:3072 nt
v_dot2_f32_bf16 v18, v104, v12, 0
v_dot2_f32_bf16 v18, v105, v13, v18
v_dot2_f32_bf16 v18, v106, v14, v18
v_dot2_f32_bf16 v18, v107, v15, v18
v_add_f32_dpp v20, v16, v16 row_ror:8 row_mask:0xf bank_mask:0x3
v_add_f32_dpp v20, v17, v17 row_ror:8 row_mask:0xf bank_mask:0xc
s_waitcnt vmcnt(4)
s_add_u32 s46, s46, 16384
s_cmp_eq_u32 s46, 0x100000
s_cselect_b32 s24, s44, s24
s_cselect_b32 s25, s45, s25
s_cselect_b32 s26, 0x200000, s26
s_add_u32 s23, s46, s22
s_and_b32 s23, s23, 0xfffff
s_and_b32 s64, s46, 0x300000
s_or_b32 s23, s23, s64
buffer_load_dwordx4 v[64:67], v5, s[24:27], s23 offen offset:0 nt
v_dot2_f32_bf16 v19, v108, v12, 0
v_dot2_f32_bf16 v19, v109, v13, v19
v_dot2_f32_bf16 v19, v110, v14, v19
v_dot2_f32_bf16 v19, v111, v15, v19
v_cndmask_b32 v29, v22, v23, s[56:57]
v_cndmask_b32 v30, v23, v22, s[56:57]
s_nop 1
v_add_f32_dpp v26, v30, v29 quad_perm:[2,3,0,1] row_mask:0xf bank_mask:0xf
s_waitcnt vmcnt(4)
buffer_load_dwordx4 v[68:71], v5, s[24:27], s23 offen offset:1024 nt
v_dot2_f32_bf16 v16, v112, v12, 0
v_dot2_f32_bf16 v16, v113, v13, v16
v_dot2_f32_bf16 v16, v114, v14, v16
v_dot2_f32_bf16 v16, v115, v15, v16
v_add_f32_dpp v21, v18, v18 row_ror:8 row_mask:0xf bank_mask:0x3
v_add_f32_dpp v21, v19, v19 row_ror:8 row_mask:0xf bank_mask:0xc
s_waitcnt vmcnt(4)
buffer_load_dwordx4 v[72:75], v5, s[24:27], s23 offen offset:2048 nt
v_dot2_f32_bf16 v17, v116, v12, 0
v_dot2_f32_bf16 v17, v117, v13, v17
v_dot2_f32_bf16 v17, v118, v14, v17
v_dot2_f32_bf16 v17, v119, v15, v17
v_add_f32_dpp v24, v20, v20 row_shl:4 row_mask:0xf bank_mask:0x5
v_add_f32_dpp v24, v21, v21 row_shr:4 row_mask:0xf bank_mask:0xa
s_waitcnt vmcnt(4)
v_dot2_f32_bf16 v18, v120, v12, 0
v_dot2_f32_bf16 v18, v121, v13, v18
v_dot2_f32_bf16 v18, v122, v14, v18
v_dot2_f32_bf16 v18, v123, v15, v18
v_add_f32_dpp v20, v16, v16 row_ror:8 row_mask:0xf bank_mask:0x3
v_add_f32_dpp v20, v17, v17 row_ror:8 row_mask:0xf bank_mask:0xc
s_waitcnt vmcnt(3)
buffer_load_dwordx4 v[76:79], v5, s[24:27], s23 offen offset:3072 nt
s_add_u32 s46, s46, 16384
s_cmp_eq_u32 s46, 0x100000
s_cselect_b32 s24, s44, s24
s_cselect_b32 s25, s45, s25
s_cselect_b32 s26, 0x200000, s26
s_add_u32 s23, s46, s22
s_and_b32 s23, s23, 0xfffff
s_and_b32 s64, s46, 0x300000
s_or_b32 s23, s23, s64
buffer_load_dwordx4 v[80:83], v5, s[24:27], s23 offen offset:0 nt
v_dot2_f32_bf16 v19, v124, v12, 0
v_dot2_f32_bf16 v19, v125, v13, v19
v_dot2_f32_bf16 v19, v126, v14, v19
v_dot2_f32_bf16 v19, v127, v15, v19
s_nop 2
v_add_f32_dpp v21, v18, v18 row_ror:8 row_mask:0xf bank_mask:0x3
v_add_f32_dpp v21, v19, v19 row_ror:8 row_mask:0xf bank_mask:0xc
s_nop 1
v_add_f32_dpp v25, v20, v20 row_shl:4 row_mask:0xf bank_mask:0x5
v_add_f32_dpp v25, v21, v21 row_shr:4 row_mask:0xf bank_mask:0xa
v_cndmask_b32 v29, v24, v25, s[56:57]
v_cndmask_b32 v30, v25, v24, s[56:57]
s_nop 1
v_add_f32_dpp v27, v30, v29 quad_perm:[2,3,0,1] row_mask:0xf bank_mask:0xf
v_cndmask_b32 v29, v26, v27, s[58:59]
v_cndmask_b32 v30, v27, v26, s[58:59]
s_nop 1
v_add_f32_dpp v28, v30, v29 quad_perm:[1,0,3,2] row_mask:0xf bank_mask:0xf
ds_write_b32 v48, v28
s_add_u32 s48, s48, 1
s_and_b32 s47, s48, 3
s_cmp_eq_u32 s47, 0
s_cselect_b32 s47, 1012, 4
v_add_u32 v48, s47, v48
s_cmp_lt_u32 s48, 16
s_cbranch_scc1 L_kloop
s_branch L_kdone
L_kloopB:
s_waitcnt vmcnt(4)
buffer_load_dwordx4 v[84:87], v5, s[24:27], s23 offen offset:1024 nt
v_dot2_f32_bf16 v16, v64, v12, 0
v_dot2_f32_bf16 v16, v65, v13, v16
v_dot2_f32_bf16 v16, v66, v14, v16
v_dot2_f32_bf16 v16, v67, v15, v16
s_waitcnt vmcnt(4)
buffer_load_dwordx4 v[88:91], v5, s[24:27], s23 offen offset:2048 nt
v_dot2_f32_bf16 v17, v68, v12, 0
v_dot2_f32_bf16 v17, v69, v13, v17
v_dot2_f32_bf16 v17, v70, v14, v17
v_dot2_f32_bf16 v17, v71, v15, v17
s_waitcnt vmcnt(4)
buffer_load_dwordx4 v[92:95], v5, s[24:27], s23 offen offset:3072 nt
v_dot2_f32_bf16 v18, v72, v12, 0
v_dot2_f32_bf16 v18, v73, v13, v18
v_dot2_f32_bf16 v18, v74, v14, v18
v_dot2_f32_bf16 v18, v75, v15, v18
v_add_f32_dpp v20, v16, v16 row_ror:8 row_mask:0xf bank_mask:0x3
v_add_f32_dpp v20, v17, v17 row_ror:8 row_mask:0xf bank_mask:0xc
s_waitcnt vmcnt(4)
s_add_u32 s46, s46, 16384
s_cmp_eq_u32 s46, 0x100000
s_cselect_b32 s24, s44, s24
s_cselect_b32 s25, s45, s25
s_cselect_b32 s26, 0x200000, s26
s_add_u32 s23, s46, s22
s_and_b32 s23, s23, 0xfffff
s_and_b32 s64, s46, 0x300000
s_or_b32 s23, s23, s64
buffer_load_dwordx4 v[96:99], v5, s[24:27], s23 offen offset:0 nt
v_dot2_f32_bf16 v19, v76, v12, 0
v_dot2_f32_bf16 v19, v77, v13, v19
v_dot2_f32_bf16 v19, v78, v14, v19
v_dot2_f32_bf16 v19, v79, v15, v19
s_waitcnt vmcnt(4)
buffer_load_dwordx4 v[100:103], v5, s[24:27], s23 offen offset:1024 nt
v_dot2_f32_bf16 v16, v80, v12, 0
v_dot2_f32_bf16 v16, v81, v13, v16
v_dot2_f32_bf16 v16, v82, v14, v16
v_dot2_f32_bf16 v16, v83, v15, v16
v_add_f32_dpp v21, v18, v18 row_ror:8 row_mask:0xf bank_mask:0x3
v_add_f32_dpp v21, v19, v19 row_ror:8 row_mask:0xf bank_mask:0xc
s_waitcnt vmcnt(4)
buffer_load_dwordx4 v[104:107], v5, s[24:27], s23 offen offset:2048 nt
v_dot2_f32_bf16 v17, v84, v12, 0
v_dot2_f32_bf16 v17, v85, v13, v17
v_dot2_f32_bf16 v17, v86, v14, v17
v_dot2_f32_bf16 v17, v87, v15, v17
v_add_f32_dpp v22, v20, v20 row_shl:4 row_mask:0xf bank_mask:0x5
v_add_f32_dpp v22, v21, v21 row_shr:4 row_mask:0xf bank_mask:0xa
s_waitcnt vmcnt(4)
buffer_load_dwordx4 v[108:111], v5, s[24:27], s23 offen offset:3072 nt
s_add_u32 s46, s46, 16384
s_cmp_eq_u32 s46, 0x100000
s_cselect_b32 s24, s44, s24
s_cselect_b32 s25, s45, s25
s_cselect_b32 s26, 0x200000, s26
s_add_u32 s23, s46, s22
s_and_b32 s23, s23, 0xfffff
s_and_b32 s64, s46, 0x300000
s_or_b32 s23, s23, s64
buffer_load_dwordx4 v[112:115], v5, s[24:27], s23 offen offset:0 nt
v_dot2_f32_bf16 v18, v88, v12, 0
v_dot2_f32_bf16 v18, v89, v13, v18
v_dot2_f32_bf16 v18, v90, v14, v18
v_dot2_f32_bf16 v18, v91, v15, v18
v_add_f32_dpp v20, v16, v16 row_ror:8 row_mask:0xf bank_mask:0x3
v_add_f32_dpp v20, v17, v17 row_ror:8 row_mask:0xf bank_mask:0xc
s_waitcnt vmcnt(5)
v_dot2_f32_bf16 v19, v92, v12, 0
v_dot2_f32_bf16 v19, v93, v13, v19
v_dot2_f32_bf16 v19, v94, v14, v19
v_dot2_f32_bf16 v19, v95, v15, v19
s_waitcnt vmcnt(4)
buffer_load_dwordx4 v[116:119], v5, s[24:27], s23 offen offset:1024 nt
v_dot2_f32_bf16 v16, v96, v12, 0
v_dot2_f32_bf16 v16, v97, v13, v16
v_dot2_f32_bf16 v16, v98, v14, v16
v_dot2_f32_bf16 v16, v99, v15, v16
v_add_f32_dpp v21, v18, v18 row_ror:8 row_mask:0xf bank_mask:0x3
v_add_f32_dpp v21, v19, v19 row_ror:8 row_mask:0xf bank_mask:0xc
s_waitcnt vmcnt(4)
buffer_load_dwordx4 v[120:123], v5, s[24:27], s23 offen offset:2048 nt
v_dot2_f32_bf16 v17, v100, v12, 0
v_dot2_f32_bf16 v17, v101, v13, v17
v_dot2_f32_bf16 v17, v102, v14, v17
v_dot2_f32_bf16 v17, v103, v15, v17
v_add_f32_dpp v23, v20, v20 row_shl:4 row_mask:0xf bank_mask:0x5
v_add_f32_dpp v23, v21, v21 row_shr:4 row_mask:0xf bank_mask:0xa
s_waitcnt vmcnt(4)
buffer_load_dwordx4 v[124:127], v5, s[24:27], s23 offen offset:3072 nt
v_dot2_f32_bf16 v18, v104, v12, 0
v_dot2_f32_bf16 v18, v105, v13, v18
v_dot2_f32_bf16 v18, v106, v14, v18
v_dot2_f32_bf16 v18, v107, v15, v18
v_add_f32_dpp v20, v16, v16 row_ror:8 row_mask:0xf bank_mask:0x3
v_add_f32_dpp v20, v17, v17 row_ror:8 row_mask:0xf bank_mask:0xc
s_waitcnt vmcnt(4)
s_add_u32 s46, s46, 16384
s_cmp_eq_u32 s46, 0x100000
s_cselect_b32 s24, s44, s24
s_cselect_b32 s25, s45, s25
s_cselect_b32 s26, 0x200000, s26
s_add_u32 s23, s46, s22
s_and_b32 s23, s23, 0xfffff
s_and_b32 s64, s46, 0x300000
s_or_b32 s23, s23, s64
buffer_load_dwordx4 v[64:67], v5, s[24:27], s23 offen offset:0 nt
v_dot2_f32_bf16 v19, v108, v12, 0
v_dot2_f32_bf16 v19, v109, v13, v19
v_dot2_f32_bf16 v19, v110, v14, v19
v_dot2_f32_bf16 v19, v111, v15, v19
v_cndmask_b32 v29, v22, v23, s[56:57]
v_cndmask_b32 v30, v23, v22, s[56:57]
s_nop 1
v_add_f32_dpp v26, v30, v29 quad_perm:[2,3,0,1] row_mask:0xf bank_mask:0xf
s_waitcnt vmcnt(4)
buffer_load_dwordx4 v[68:71], v5, s[24:27], s23 offen offset:1024 nt
v_dot2_f32_bf16 v16, v112, v12, 0
v_dot2_f32_bf16 v16, v113, v13, v16
v_dot2_f32_bf16 v16, v114, v14, v16
v_dot2_f32_bf16 v16, v115, v15, v16
v_add_f32_dpp v21, v18, v18 row_ror:8 row_mask:0xf bank_mask:0x3
v_add_f32_dpp v21, v19, v19 row_ror:8 row_mask:0xf bank_mask:0xc
s_waitcnt vmcnt(4)
buffer_load_dwordx4 v[72:75], v5, s[24:27], s23 offen offset:2048 nt
v_dot2_f32_bf16 v17, v116, v12, 0
v_dot2_f32_bf16 v17, v117, v13, v17
v_dot2_f32_bf16 v17, v118, v14, v17
v_dot2_f32_bf16 v17, v119, v15, v17
v_add_f32_dpp v24, v20, v20 row_shl:4 row_mask:0xf bank_mask:0x5
v_add_f32_dpp v24, v21, v21 row_shr:4 row_mask:0xf bank_mask:0xa
s_waitcnt vmcnt(4)
buffer_load_dwordx4 v[76:79], v5, s[24:27], s23 offen offset:3072 nt
s_add_u32 s46, s46, 16384
s_cmp_eq_u32 s46, 0x100000
s_cselect_b32 s24, s44, s24
s_cselect_b32 s25, s45, s25
s_cselect_b32 s26, 0x200000, s26
s_add_u32 s23, s46, s22
s_and_b32 s23, s23, 0xfffff
s_and_b32 s64, s46, 0x300000
s_or_b32 s23, s23, s64
buffer_load_dwordx4 v[80:83], v5, s[24:27], s23 offen offset:0 nt
v_dot2_f32_bf16 v18, v120, v12, 0
v_dot2_f32_bf16 v18, v121, v13, v18
v_dot2_f32_bf16 v18, v122, v14, v18
v_dot2_f32_bf16 v18, v123, v15, v18
v_add_f32_dpp v20, v16, v16 row_ror:8 row_mask:0xf bank_mask:0x3
v_add_f32_dpp v20, v17, v17 row_ror:8 row_mask:0xf bank_mask:0xc
s_waitcnt vmcnt(5)
v_dot2_f32_bf16 v19, v124, v12, 0
v_dot2_f32_bf16 v19, v125, v13, v19
v_dot2_f32_bf16 v19, v126, v14, v19
v_dot2_f32_bf16 v19, v127, v15, v19
s_nop 2
v_add_f32_dpp v21, v18, v18 row_ror:8 row_mask:0xf bank_mask:0x3
v_add_f32_dpp v21, v19, v19 row_ror:8 row_mask:0xf bank_mask:0xc
s_nop 1
v_add_f32_dpp v25, v20, v20 row_shl:4 row_mask:0xf bank_mask:0x5
v_add_f32_dpp v25, v21, v21 row_shr:4 row_mask:0xf bank_mask:0xa
v_cndmask_b32 v29, v24, v25, s[56:57]
v_cndmask_b32 v30, v25, v24, s[56:57]
s_nop 1
v_add_f32_dpp v27, v30, v29 quad_perm:[2,3,0,1] row_mask:0xf bank_mask:0xf
v_cndmask_b32 v29, v26, v27, s[58:59]
v_cndmask_b32 v30, v27, v26, s[58:59]
s_nop 1
v_add_f32_dpp v28, v30, v29 quad_perm:[1,0,3,2] row_mask:0xf bank_mask:0xf
ds_write_b32 v48, v28
s_add_u32 s48, s48, 1
s_and_b32 s47, s48, 3
s_cmp_eq_u32 s47, 0
s_cselect_b32 s47, 1012, 4
v_add_u32 v48, s47, v48
s_cmp_lt_u32 s48, 16
s_cbranch_scc1 L_kdisp
L_kdone:
s_waitcnt lgkmcnt(0)
ds_read_b128 v[128:131], v6 offset:0
ds_read_b128 v[132:135], v6 offset:1024
ds_read_b128 v[136:139], v6 offset:2048
ds_read_b128 v[140:143], v6 offset:3072
s_waitcnt lgkmcnt(0)
v_max3_f32 v29, v128, v129, v130
v_max3_f32 v29, v29, v131, v132
v_max3_f32 v29, v29, v133, v134
v_max3_f32 v29, v29, v135, v136
v_max3_f32 v29, v29, v137, v138
v_max3_f32 v29, v29, v139, v140
v_max3_f32 v29, v29, v141, v142
v_max_f32 v29, v29, v143
s_nop 1
v_max_f32_dpp v29, v29, v29 row_ror:8 row_mask:0xf bank_mask:0xf
s_nop 1
v_max_f32_dpp v29, v29, v29 row_ror:4 row_mask:0xf bank_mask:0xf
s_nop 1
v_max_f32_dpp v29, v29, v29 row_ror:2 row_mask:0xf bank_mask:0xf
s_nop 1
v_max_f32_dpp v29, v29, v29 row_ror:1 row_mask:0xf bank_mask:0xf
v_mov_b32 v30, v29
s_nop 1
v_permlane16_swap_b32 v29, v30
s_nop 1
v_max_f32 v29, v29, v30
v_mov_b32 v30, v29
s_nop 1
v_permlane32_swap_b32 v29, v30
s_nop 1
v_max_f32 v29, v29, v30
v_mul_f32 v33, s60, v29
v_fma_f32 v128, v128, s60, -v33
v_fma_f32 v129, v129, s60, -v33
v_fma_f32 v130, v130, s60, -v33
v_fma_f32 v131, v131, s60, -v33
v_fma_f32 v132, v132, s60, -v33
v_fma_f32 v133, v133, s60, -v33
v_fma_f32 v134, v134, s60, -v33
v_fma_f32 v135, v135, s60, -v33
v_fma_f32 v136, v136, s60, -v33
v_fma_f32 v137, v137, s60, -v33
v_fma_f32 v138, v138, s60, -v33
v_fma_f32 v139, v139, s60, -v33
v_fma_f32 v140, v140, s60, -v33
v_fma_f32 v141, v141, s60, -v33
v_fma_f32 v142, v142, s60, -v33
v_fma_f32 v143, v143, s60, -v33
v_exp_f32 v128, v128
v_exp_f32 v129, v129
v_exp_f32 v130, v130
v_exp_f32 v131, v131
v_exp_f32 v132, v132
v_exp_f32 v133, v133
v_exp_f32 v134, v134
v_exp_f32 v135, v135
v_exp_f32 v136, v136
v_exp_f32 v137, v137
v_exp_f32 v138, v138
v_exp_f32 v139, v139
v_exp_f32 v140, v140
v_exp_f32 v141, v141
v_exp_f32 v142, v142
v_exp_f32 v143, v143
s_nop 0
v_cvt_pk_bf16_f32 v144, v128, v128
v_cvt_pk_bf16_f32 v145, v129, v129
v_cvt_pk_bf16_f32 v146, v130, v130
v_cvt_pk_bf16_f32 v147, v131, v131
v_cvt_pk_bf16_f32 v148, v132, v132
v_cvt_pk_bf16_f32 v149, v133, v133
v_cvt_pk_bf16_f32 v150, v134, v134
v_cvt_pk_bf16_f32 v151, v135, v135
v_cvt_pk_bf16_f32 v152, v136, v136
v_cvt_pk_bf16_f32 v153, v137, v137
v_cvt_pk_bf16_f32 v154, v138, v138
v_cvt_pk_bf16_f32 v155, v139, v139
v_cvt_pk_bf16_f32 v156, v140, v140
v_cvt_pk_bf16_f32 v157, v141, v141
v_cvt_pk_bf16_f32 v158, v142, v142
v_cvt_pk_bf16_f32 v159, v143, v143
ds_write_b128 v6, v[144:147] offset:0
ds_write_b128 v6, v[148:151] offset:1024
ds_write_b128 v6, v[152:155] offset:2048
ds_write_b128 v6, v[156:159] offset:3072
v_add_f32 v128, v128, v136
v_add_f32 v129, v129, v137
v_add_f32 v130, v130, v138
v_add_f32 v131, v131, v139
v_add_f32 v132, v132, v140
v_add_f32 v133, v133, v141
v_add_f32 v134, v134, v142
v_add_f32 v135, v135, v143
v_add_f32 v128, v128, v132
v_add_f32 v129, v129, v133
v_add_f32 v130, v130, v134
v_add_f32 v131, v131, v135
v_add_f32 v128, v128, v130
v_add_f32 v129, v129, v131
v_add_f32 v28, v128, v129
s_nop 1
v_add_f32_dpp v28, v28, v28 row_ror:8 row_mask:0xf bank_mask:0xf
s_nop 1
v_add_f32_dpp v28, v28, v28 row_ror:4 row_mask:0xf bank_mask:0xf
s_nop 1
v_add_f32_dpp v28, v28, v28 row_ror:2 row_mask:0xf bank_mask:0xf
s_nop 1
v_add_f32_dpp v28, v28, v28 row_ror:1 row_mask:0xf bank_mask:0xf
v_mov_b32 v30, v28
s_nop 1
v_permlane16_swap_b32 v28, v30
s_nop 1
v_add_f32 v28, v28, v30
v_mov_b32 v30, v28
s_nop 1
v_permlane32_swap_b32 v28, v30
s_nop 1
v_add_f32 v28, v28, v30
v_mov_b32 v29, 0x7fc00000
v_cmp_eq_u32 s[68:69], -1, v33
v_cmp_eq_u32 s[70:71], -1, v28
v_lshlrev_b32 v30, 2, v4
s_nop 0
v_cndmask_b32 v33, v33, v29, s[68:69]
v_cndmask_b32 v28, v28, v29, s[70:71]
s_mov_b64 exec, 1
ds_write_b32 v30, v33 offset:20480
ds_write_b32 v30, v28 offset:20496
s_mov_b64 exec, -1
v_mov_b32 v31, v144
v_mov_b32 v48, v6
s_mov_b32 s48, 0
s_getreg_b32 s70, hwreg(HW_REG_XCC_ID)
s_and_b32 s70, s70, 1
s_xor_b32 s70, s70, 1
s_lshl_b32 s70, s70, 5
s_mov_b32 s71, 0
L_vloop:
s_add_u32 s48, s48, 1
s_and_b32 s47, s48, 3
s_cmp_eq_u32 s47, 0
s_cselect_b32 s47, 1012, 4
v_add_u32 v48, s47, v48
s_waitcnt lgkmcnt(0)
ds_read_b32 v32, v48
s_cmp_eq_u32 s48, 12
s_cbranch_scc1 L_mlx
L_mlx_ret:
s_cmp_lt_u32 s71, s70
s_cbranch_scc1 L_vB
s_waitcnt vmcnt(4)
buffer_load_dwordx4 v[84:87], v5, s[24:27], s23 offen offset:1024 nt
v_and_b32_dpp v36, v31, v8 row_newbcast:0 row_mask:0xf bank_mask:0xf
v_and_b32_dpp v37, v31, v9 row_newbcast:0 row_mask:0xf bank_mask:0xf
v_and_b32_dpp v38, v31, v10 row_newbcast:0 row_mask:0xf bank_mask:0xf
v_and_b32_dpp v39, v31, v11 row_newbcast:0 row_mask:0xf bank_mask:0xf
s_nop 1
v_mfma_f32_16x16x32_bf16 v[44:47], v[36:39], v[64:67], v[44:47]
s_waitcnt vmcnt(4)
buffer_load_dwordx4 v[88:91], v5, s[24:27], s23 offen offset:2048 nt
v_and_b32_dpp v40, v31, v8 row_newbcast:8 row_mask:0xf bank_mask:0xf
v_and_b32_dpp v41, v31, v9 row_newbcast:8 row_mask:0xf bank_mask:0xf
v_and_b32_dpp v42, v31, v10 row_newbcast:8 row_mask:0xf bank_mask:0xf
v_and_b32_dpp v43, v31, v11 row_newbcast:8 row_mask:0xf bank_mask:0xf
s_nop 1
v_mfma_f32_16x16x32_bf16 v[44:47], v[40:43], v[68:71], v[44:47]
s_waitcnt vmcnt(4)
buffer_load_dwordx4 v[92:95], v5, s[24:27], s23 offen offset:3072 nt
v_and_b32_dpp v36, v31, v8 row_newbcast:4 row_mask:0xf bank_mask:0xf
v_and_b32_dpp v37, v31, v9 row_newbcast:4 row_mask:0xf bank_mask:0xf
v_and_b32_dpp v38, v31, v10 row_newbcast:4 row_mask:0xf bank_mask:0xf
v_and_b32_dpp v39, v31, v11 row_newbcast:4 row_mask:0xf bank_mask:0xf
s_nop 1
v_mfma_f32_16x16x32_bf16 v[44:47], v[36:39], v[72:75], v[44:47]
s_waitcnt vmcnt(4)
s_add_u32 s46, s46, 16384
s_add_u32 s23, s46, s22
s_and_b32 s23, s23, 0xfffff
s_and_b32 s64, s46, 0x300000
s_or_b32 s23, s23, s64
buffer_load_dwordx4 v[96:99], v5, s[24:27], s23 offen offset:0 nt
v_and_b32_dpp v40, v31, v8 row_newbcast:12 row_mask:0xf bank_mask:0xf
v_and_b32_dpp v41, v31, v9 row_newbcast:12 row_mask:0xf bank_mask:0xf
v_and_b32_dpp v42, v31, v10 row_newbcast:12 row_mask:0xf bank_mask:0xf
v_and_b32_dpp v43, v31, v11 row_newbcast:12 row_mask:0xf bank_mask:0xf
s_nop 1
v_mfma_f32_16x16x32_bf16 v[44:47], v[40:43], v[76:79], v[44:47]
s_waitcnt vmcnt(4)
buffer_load_dwordx4 v[100:103], v5, s[24:27], s23 offen offset:1024 nt
v_and_b32_dpp v36, v31, v8 row_newbcast:2 row_mask:0xf bank_mask:0xf
v_and_b32_dpp v37, v31, v9 row_newbcast:2 row_mask:0xf bank_mask:0xf
v_and_b32_dpp v38, v31, v10 row_newbcast:2 row_mask:0xf bank_mask:0xf
v_and_b32_dpp v39, v31, v11 row_newbcast:2 row_mask:0xf bank_mask:0xf
s_nop 1
v_mfma_f32_16x16x32_bf16 v[44:47], v[36:39], v[80:83], v[44:47]
s_waitcnt vmcnt(4)
buffer_load_dwordx4 v[104:107], v5, s[24:27], s23 offen offset:2048 nt
v_and_b32_dpp v40, v31, v8 row_newbcast:10 row_mask:0xf bank_mask:0xf
v_and_b32_dpp v41, v31, v9 row_newbcast:10 row_mask:0xf bank_mask:0xf
v_and_b32_dpp v42, v31, v10 row_newbcast:10 row_mask:0xf bank_mask:0xf
v_and_b32_dpp v43, v31, v11 row_newbcast:10 row_mask:0xf bank_mask:0xf
s_nop 1
v_mfma_f32_16x16x32_bf16 v[44:47], v[40:43], v[84:87], v[44:47]
s_waitcnt vmcnt(4)
v_and_b32_dpp v36, v31, v8 row_newbcast:6 row_mask:0xf bank_mask:0xf
v_and_b32_dpp v37, v31, v9 row_newbcast:6 row_mask:0xf bank_mask:0xf
v_and_b32_dpp v38, v31, v10 row_newbcast:6 row_mask:0xf bank_mask:0xf
v_and_b32_dpp v39, v31, v11 row_newbcast:6 row_mask:0xf bank_mask:0xf
s_nop 1
v_mfma_f32_16x16x32_bf16 v[44:47], v[36:39], v[88:91], v[44:47]
s_waitcnt vmcnt(3)
buffer_load_dwordx4 v[108:111], v5, s[24:27], s23 offen offset:3072 nt
s_add_u32 s46, s46, 16384
s_add_u32 s23, s46, s22
s_and_b32 s23, s23, 0xfffff
s_and_b32 s64, s46, 0x300000
s_or_b32 s23, s23, s64
buffer_load_dwordx4 v[112:115], v5, s[24:27], s23 offen offset:0 nt
v_and_b32_dpp v40, v31, v8 row_newbcast:14 row_mask:0xf bank_mask:0xf
v_and_b32_dpp v41, v31, v9 row_newbcast:14 row_mask:0xf bank_mask:0xf
v_and_b32_dpp v42, v31, v10 row_newbcast:14 row_mask:0xf bank_mask:0xf
v_and_b32_dpp v43, v31, v11 row_newbcast:14 row_mask:0xf bank_mask:0xf
s_nop 1
v_mfma_f32_16x16x32_bf16 v[44:47], v[40:43], v[92:95], v[44:47]
s_waitcnt vmcnt(4)
buffer_load_dwordx4 v[116:119], v5, s[24:27], s23 offen offset:1024 nt
v_and_b32_dpp v36, v31, v8 row_newbcast:1 row_mask:0xf bank_mask:0xf
v_and_b32_dpp v37, v31, v9 row_newbcast:1 row_mask:0xf bank_mask:0xf
v_and_b32_dpp v38, v31, v10 row_newbcast:1 row_mask:0xf bank_mask:0xf
v_and_b32_dpp v39, v31, v11 row_newbcast:1 row_mask:0xf bank_mask:0xf
s_nop 1
v_mfma_f32_16x16x32_bf16 v[44:47], v[36:39], v[96:99], v[44:47]
s_waitcnt vmcnt(4)
buffer_load_dwordx4 v[120:123], v5, s[24:27], s23 offen offset:2048 nt
v_and_b32_dpp v40, v31, v8 row_newbcast:9 row_mask:0xf bank_mask:0xf
v_and_b32_dpp v41, v31, v9 row_newbcast:9 row_mask:0xf bank_mask:0xf
v_and_b32_dpp v42, v31, v10 row_newbcast:9 row_mask:0xf bank_mask:0xf
v_and_b32_dpp v43, v31, v11 row_newbcast:9 row_mask:0xf bank_mask:0xf
s_nop 1
v_mfma_f32_16x16x32_bf16 v[44:47], v[40:43], v[100:103], v[44:47]
s_waitcnt vmcnt(4)
buffer_load_dwordx4 v[124:127], v5, s[24:27], s23 offen offset:3072 nt
v_and_b32_dpp v36, v31, v8 row_newbcast:5 row_mask:0xf bank_mask:0xf
v_and_b32_dpp v37, v31, v9 row_newbcast:5 row_mask:0xf bank_mask:0xf
v_and_b32_dpp v38, v31, v10 row_newbcast:5 row_mask:0xf bank_mask:0xf
v_and_b32_dpp v39, v31, v11 row_newbcast:5 row_mask:0xf bank_mask:0xf
s_nop 1
v_mfma_f32_16x16x32_bf16 v[44:47], v[36:39], v[104:107], v[44:47]
s_waitcnt vmcnt(4)
s_add_u32 s46, s46, 16384
s_add_u32 s23, s46, s22
s_and_b32 s23, s23, 0xfffff
s_and_b32 s64, s46, 0x300000
s_or_b32 s23, s23, s64
buffer_load_dwordx4 v[64:67], v5, s[24:27], s23 offen offset:0 nt
v_and_b32_dpp v40, v31, v8 row_newbcast:13 row_mask:0xf bank_mask:0xf
v_and_b32_dpp v41, v31, v9 row_newbcast:13 row_mask:0xf bank_mask:0xf
v_and_b32_dpp v42, v31, v10 row_newbcast:13 row_mask:0xf bank_mask:0xf
v_and_b32_dpp v43, v31, v11 row_newbcast:13 row_mask:0xf bank_mask:0xf
s_nop 1
v_mfma_f32_16x16x32_bf16 v[44:47], v[40:43], v[108:111], v[44:47]
s_waitcnt vmcnt(4)
buffer_load_dwordx4 v[68:71], v5, s[24:27], s23 offen offset:1024 nt
v_and_b32_dpp v36, v31, v8 row_newbcast:3 row_mask:0xf bank_mask:0xf
v_and_b32_dpp v37, v31, v9 row_newbcast:3 row_mask:0xf bank_mask:0xf
v_and_b32_dpp v38, v31, v10 row_newbcast:3 row_mask:0xf bank_mask:0xf
v_and_b32_dpp v39, v31, v11 row_newbcast:3 row_mask:0xf bank_mask:0xf
s_nop 1
v_mfma_f32_16x16x32_bf16 v[44:47], v[36:39], v[112:115], v[44:47]
s_waitcnt vmcnt(4)
buffer_load_dwordx4 v[72:75], v5, s[24:27], s23 offen offset:2048 nt
v_and_b32_dpp v40, v31, v8 row_newbcast:11 row_mask:0xf bank_mask:0xf
v_and_b32_dpp v41, v31, v9 row_newbcast:11 row_mask:0xf bank_mask:0xf
v_and_b32_dpp v42, v31, v10 row_newbcast:11 row_mask:0xf bank_mask:0xf
v_and_b32_dpp v43, v31, v11 row_newbcast:11 row_mask:0xf bank_mask:0xf
s_nop 1
v_mfma_f32_16x16x32_bf16 v[44:47], v[40:43], v[116:119], v[44:47]
s_waitcnt vmcnt(4)
v_and_b32_dpp v36, v31, v8 row_newbcast:7 row_mask:0xf bank_mask:0xf
v_and_b32_dpp v37, v31, v9 row_newbcast:7 row_mask:0xf bank_mask:0xf
v_and_b32_dpp v38, v31, v10 row_newbcast:7 row_mask:0xf bank_mask:0xf
v_and_b32_dpp v39, v31, v11 row_newbcast:7 row_mask:0xf bank_mask:0xf
s_nop 1
v_mfma_f32_16x16x32_bf16 v[44:47], v[36:39], v[120:123], v[44:47]
s_waitcnt vmcnt(3)
buffer_load_dwordx4 v[76:79], v5, s[24:27], s23 offen offset:3072 nt
s_add_u32 s46, s46, 16384
s_add_u32 s23, s46, s22
s_and_b32 s23, s23, 0xfffff
s_and_b32 s64, s46, 0x300000
s_or_b32 s23, s23, s64
buffer_load_dwordx4 v[80:83], v5, s[24:27], s23 offen offset:0 nt
v_and_b32_dpp v40, v31, v8 row_newbcast:15 row_mask:0xf bank_mask:0xf
v_and_b32_dpp v41, v31, v9 row_newbcast:15 row_mask:0xf bank_mask:0xf
v_and_b32_dpp v42, v31, v10 row_newbcast:15 row_mask:0xf bank_mask:0xf
v_and_b32_dpp v43, v31, v11 row_newbcast:15 row_mask:0xf bank_mask:0xf
s_nop 1
v_mfma_f32_16x16x32_bf16 v[44:47], v[40:43], v[124:127], v[44:47]
s_branch L_vE
L_vB:
s_add_u32 s71, s71, 1
s_waitcnt vmcnt(4)
buffer_load_dwordx4 v[84:87], v5, s[24:27], s23 offen offset:1024 nt
v_and_b32_dpp v36, v31, v8 row_newbcast:0 row_mask:0xf bank_mask:0xf
v_and_b32_dpp v37, v31, v9 row_newbcast:0 row_mask:0xf bank_mask:0xf
v_and_b32_dpp v38, v31, v10 row_newbcast:0 row_mask:0xf bank_mask:0xf
v_and_b32_dpp v39, v31, v11 row_newbcast:0 row_mask:0xf bank_mask:0xf
s_nop 1
v_mfma_f32_16x16x32_bf16 v[44:47], v[36:39], v[64:67], v[44:47]
s_waitcnt vmcnt(4)
buffer_load_dwordx4 v[88:91], v5, s[24:27], s23 offen offset:2048 nt
v_and_b32_dpp v40, v31, v8 row_newbcast:8 row_mask:0xf bank_mask:0xf
v_and_b32_dpp v41, v31, v9 row_newbcast:8 row_mask:0xf bank_mask:0xf
v_and_b32_dpp v42, v31, v10 row_newbcast:8 row_mask:0xf bank_mask:0xf
v_and_b32_dpp v43, v31, v11 row_newbcast:8 row_mask:0xf bank_mask:0xf
s_nop 1
v_mfma_f32_16x16x32_bf16 v[44:47], v[40:43], v[68:71], v[44:47]
s_waitcnt vmcnt(4)
buffer_load_dwordx4 v[92:95], v5, s[24:27], s23 offen offset:3072 nt
v_and_b32_dpp v36, v31, v8 row_newbcast:4 row_mask:0xf bank_mask:0xf
v_and_b32_dpp v37, v31, v9 row_newbcast:4 row_mask:0xf bank_mask:0xf
v_and_b32_dpp v38, v31, v10 row_newbcast:4 row_mask:0xf bank_mask:0xf
v_and_b32_dpp v39, v31, v11 row_newbcast:4 row_mask:0xf bank_mask:0xf
s_nop 1
v_mfma_f32_16x16x32_bf16 v[44:47], v[36:39], v[72:75], v[44:47]
s_waitcnt vmcnt(4)
s_add_u32 s46, s46, 16384
s_add_u32 s23, s46, s22
s_and_b32 s23, s23, 0xfffff
s_and_b32 s64, s46, 0x300000
s_or_b32 s23, s23, s64
buffer_load_dwordx4 v[96:99], v5, s[24:27], s23 offen offset:0 nt
v_and_b32_dpp v40, v31, v8 row_newbcast:12 row_mask:0xf bank_mask:0xf
v_and_b32_dpp v41, v31, v9 row_newbcast:12 row_mask:0xf bank_mask:0xf
v_and_b32_dpp v42, v31, v10 row_newbcast:12 row_mask:0xf bank_mask:0xf
v_and_b32_dpp v43, v31, v11 row_newbcast:12 row_mask:0xf bank_mask:0xf
s_nop 1
v_mfma_f32_16x16x32_bf16 v[44:47], v[40:43], v[76:79], v[44:47]
s_waitcnt vmcnt(4)
buffer_load_dwordx4 v[100:103], v5, s[24:27], s23 offen offset:1024 nt
v_and_b32_dpp v36, v31, v8 row_newbcast:2 row_mask:0xf bank_mask:0xf
v_and_b32_dpp v37, v31, v9 row_newbcast:2 row_mask:0xf bank_mask:0xf
v_and_b32_dpp v38, v31, v10 row_newbcast:2 row_mask:0xf bank_mask:0xf
v_and_b32_dpp v39, v31, v11 row_newbcast:2 row_mask:0xf bank_mask:0xf
s_nop 1
v_mfma_f32_16x16x32_bf16 v[44:47], v[36:39], v[80:83], v[44:47]
s_waitcnt vmcnt(4)
buffer_load_dwordx4 v[104:107], v5, s[24:27], s23 offen offset:2048 nt
v_and_b32_dpp v40, v31, v8 row_newbcast:10 row_mask:0xf bank_mask:0xf
v_and_b32_dpp v41, v31, v9 row_newbcast:10 row_mask:0xf bank_mask:0xf
v_and_b32_dpp v42, v31, v10 row_newbcast:10 row_mask:0xf bank_mask:0xf
v_and_b32_dpp v43, v31, v11 row_newbcast:10 row_mask:0xf bank_mask:0xf
s_nop 1
v_mfma_f32_16x16x32_bf16 v[44:47], v[40:43], v[84:87], v[44:47]
s_waitcnt vmcnt(4)
buffer_load_dwordx4 v[108:111], v5, s[24:27], s23 offen offset:3072 nt
v_and_b32_dpp v36, v31, v8 row_newbcast:6 row_mask:0xf bank_mask:0xf
v_and_b32_dpp v37, v31, v9 row_newbcast:6 row_mask:0xf bank_mask:0xf
v_and_b32_dpp v38, v31, v10 row_newbcast:6 row_mask:0xf bank_mask:0xf
v_and_b32_dpp v39, v31, v11 row_newbcast:6 row_mask:0xf bank_mask:0xf
s_nop 1
v_mfma_f32_16x16x32_bf16 v[44:47], v[36:39], v[88:91], v[44:47]
s_waitcnt vmcnt(4)
s_add_u32 s46, s46, 16384
s_add_u32 s23, s46, s22
s_and_b32 s23, s23, 0xfffff
s_and_b32 s64, s46, 0x300000
s_or_b32 s23, s23, s64
buffer_load_dwordx4 v[112:115], v5, s[24:27], s23 offen offset:0 nt
v_and_b32_dpp v40, v31, v8 row_newbcast:14 row_mask:0xf bank_mask:0xf
v_and_b32_dpp v41, v31, v9 row_newbcast:14 row_mask:0xf bank_mask:0xf
v_and_b32_dpp v42, v31, v10 row_newbcast:14 row_mask:0xf bank_mask:0xf
v_and_b32_dpp v43, v31, v11 row_newbcast:14 row_mask:0xf bank_mask:0xf
s_nop 1
v_mfma_f32_16x16x32_bf16 v[44:47], v[40:43], v[92:95], v[44:47]
s_waitcnt vmcnt(4)
buffer_load_dwordx4 v[116:119], v5, s[24:27], s23 offen offset:1024 nt
v_and_b32_dpp v36, v31, v8 row_newbcast:1 row_mask:0xf bank_mask:0xf
v_and_b32_dpp v37, v31, v9 row_newbcast:1 row_mask:0xf bank_mask:0xf
v_and_b32_dpp v38, v31, v10 row_newbcast:1 row_mask:0xf bank_mask:0xf
v_and_b32_dpp v39, v31, v11 row_newbcast:1 row_mask:0xf bank_mask:0xf
s_nop 1
v_mfma_f32_16x16x32_bf16 v[44:47], v[36:39], v[96:99], v[44:47]
s_waitcnt vmcnt(4)
buffer_load_dwordx4 v[120:123], v5, s[24:27], s23 offen offset:2048 nt
v_and_b32_dpp v40, v31, v8 row_newbcast:9 row_mask:0xf bank_mask:0xf
v_and_b32_dpp v41, v31, v9 row_newbcast:9 row_mask:0xf bank_mask:0xf
v_and_b32_dpp v42, v31, v10 row_newbcast:9 row_mask:0xf bank_mask:0xf
v_and_b32_dpp v43, v31, v11 row_newbcast:9 row_mask:0xf bank_mask:0xf
s_nop 1
v_mfma_f32_16x16x32_bf16 v[44:47], v[40:43], v[100:103], v[44:47]
s_waitcnt vmcnt(4)
buffer_load_dwordx4 v[124:127], v5, s[24:27], s23 offen offset:3072 nt
v_and_b32_dpp v36, v31, v8 row_newbcast:5 row_mask:0xf bank_mask:0xf
v_and_b32_dpp v37, v31, v9 row_newbcast:5 row_mask:0xf bank_mask:0xf
v_and_b32_dpp v38, v31, v10 row_newbcast:5 row_mask:0xf bank_mask:0xf
v_and_b32_dpp v39, v31, v11 row_newbcast:5 row_mask:0xf bank_mask:0xf
s_nop 1
v_mfma_f32_16x16x32_bf16 v[44:47], v[36:39], v[104:107], v[44:47]
s_waitcnt vmcnt(4)
s_add_u32 s46, s46, 16384
s_add_u32 s23, s46, s22
s_and_b32 s23, s23, 0xfffff
s_and_b32 s64, s46, 0x300000
s_or_b32 s23, s23, s64
buffer_load_dwordx4 v[64:67], v5, s[24:27], s23 offen offset:0 nt
v_and_b32_dpp v40, v31, v8 row_newbcast:13 row_mask:0xf bank_mask:0xf
v_and_b32_dpp v41, v31, v9 row_newbcast:13 row_mask:0xf bank_mask:0xf
v_and_b32_dpp v42, v31, v10 row_newbcast:13 row_mask:0xf bank_mask:0xf
v_and_b32_dpp v43, v31, v11 row_newbcast:13 row_mask:0xf bank_mask:0xf
s_nop 1
v_mfma_f32_16x16x32_bf16 v[44:47], v[40:43], v[108:111], v[44:47]
s_waitcnt vmcnt(4)
buffer_load_dwordx4 v[68:71], v5, s[24:27], s23 offen offset:1024 nt
v_and_b32_dpp v36, v31, v8 row_newbcast:3 row_mask:0xf bank_mask:0xf
v_and_b32_dpp v37, v31, v9 row_newbcast:3 row_mask:0xf bank_mask:0xf
v_and_b32_dpp v38, v31, v10 row_newbcast:3 row_mask:0xf bank_mask:0xf
v_and_b32_dpp v39, v31, v11 row_newbcast:3 row_mask:0xf bank_mask:0xf
s_nop 1
v_mfma_f32_16x16x32_bf16 v[44:47], v[36:39], v[112:115], v[44:47]
s_waitcnt vmcnt(4)
buffer_load_dwordx4 v[72:75], v5, s[24:27], s23 offen offset:2048 nt
v_and_b32_dpp v40, v31, v8 row_newbcast:11 row_mask:0xf bank_mask:0xf
v_and_b32_dpp v41, v31, v9 row_newbcast:11 row_mask:0xf bank_mask:0xf
v_and_b32_dpp v42, v31, v10 row_newbcast:11 row_mask:0xf bank_mask:0xf
v_and_b32_dpp v43, v31, v11 row_newbcast:11 row_mask:0xf bank_mask:0xf
s_nop 1
v_mfma_f32_16x16x32_bf16 v[44:47], v[40:43], v[116:119], v[44:47]
s_waitcnt vmcnt(4)
buffer_load_dwordx4 v[76:79], v5, s[24:27], s23 offen offset:3072 nt
v_and_b32_dpp v36, v31, v8 row_newbcast:7 row_mask:0xf bank_mask:0xf
v_and_b32_dpp v37, v31, v9 row_newbcast:7 row_mask:0xf bank_mask:0xf
v_and_b32_dpp v38, v31, v10 row_newbcast:7 row_mask:0xf bank_mask:0xf
v_and_b32_dpp v39, v31, v11 row_newbcast:7 row_mask:0xf bank_mask:0xf
s_nop 1
v_mfma_f32_16x16x32_bf16 v[44:47], v[36:39], v[120:123], v[44:47]
s_waitcnt vmcnt(4)
s_add_u32 s46, s46, 16384
s_add_u32 s23, s46, s22
s_and_b32 s23, s23, 0xfffff
s_and_b32 s64, s46, 0x300000
s_or_b32 s23, s23, s64
buffer_load_dwordx4 v[80:83], v5, s[24:27], s23 offen offset:0 nt
v_and_b32_dpp v40, v31, v8 row_newbcast:15 row_mask:0xf bank_mask:0xf
v_and_b32_dpp v41, v31, v9 row_newbcast:15 row_mask:0xf bank_mask:0xf
v_and_b32_dpp v42, v31, v10 row_newbcast:15 row_mask:0xf bank_mask:0xf
v_and_b32_dpp v43, v31, v11 row_newbcast:15 row_mask:0xf bank_mask:0xf
s_nop 1
v_mfma_f32_16x16x32_bf16 v[44:47], v[40:43], v[124:127], v[44:47]
L_vE:
s_waitcnt lgkmcnt(0)
v_mov_b32 v31, v32
s_cmp_lt_u32 s48, 16
s_cbranch_scc1 L_vloop
v_lshl_add_u32 v29, v4, 9, v7
s_nop 6
v_mul_f32 v44, v44, v34
v_mul_f32 v45, v45, v34
v_mul_f32 v46, v46, v34
v_mul_f32 v47, v47, v34
s_mov_b32 exec_hi, 0
ds_write_b128 v29, v[44:47] offset:18432
s_mov_b32 exec_hi, -1
s_waitcnt lgkmcnt(0)
s_barrier
s_endpgm
L_mlx:
s_mov_b32 s67, 0
v_mov_b32 v29, 0
L_mlx_spin:
ds_read_b128 v[128:131], v29 offset:20480
ds_read_b128 v[132:135], v29 offset:20496
s_waitcnt lgkmcnt(0)
v_max3_u32 v30, v128, v129, v130
v_max3_u32 v30, v30, v131, v132
v_max3_u32 v30, v30, v133, v134
v_max_u32 v30, v30, v135
v_cmp_eq_u32 vcc, -1, v30
s_add_u32 s67, s67, 1
s_cmp_ge_u32 s67, 1000000
s_cbranch_scc1 L_mlx_go
s_cbranch_vccnz L_mlx_spin
L_mlx_go:
v_max3_f32 v30, v128, v129, v130
v_max_f32 v30, v30, v131
v_sub_f32 v34, v33, v30
v_exp_f32 v34, v34
s_branch L_mlx_ret
L_helper:
s_sub_u32 s48, s49, 4
v_subrev_u32 v5, 4, v4
s_lshl_b32 s54, s50, 1
s_add_u32 s54, s54, s52
s_lshl_b32 s55, s51, 1
s_add_u32 s55, s55, s53
s_lshl_b32 s66, s54, 6
s_add_u32 s66, s66, s55
s_lshl_b32 s93, s50, 5
s_add_u32 s93, s93, s51
v_and_b32 v29, 1, v2
v_lshlrev_b32 v29, 4, v29
v_mov_b32 v30, 0xffff
v_lshlrev_b32 v30, v29, v30
v_and_b32 v29, 15, v2
v_lshrrev_b32 v29, 1, v29
v_cmp_eq_u32 s[68:69], 0, v29
v_cmp_eq_u32 s[70:71], 1, v29
v_cmp_eq_u32 s[72:73], 2, v29
v_cmp_eq_u32 s[74:75], 3, v29
s_nop 1
v_cndmask_b32 v8, 0, v30, s[68:69]
v_cndmask_b32 v9, 0, v30, s[70:71]
v_cndmask_b32 v10, 0, v30, s[72:73]
v_cndmask_b32 v11, 0, v30, s[74:75]
v_lshlrev_b32 v7, 5, v2
v_lshl_add_u32 v7, v3, 4, v7
v_lshlrev_b32 v50, 15, v3
v_lshl_add_u32 v50, v5, 8, v50
v_lshl_add_u32 v50, v2, 4, v50
s_waitcnt lgkmcnt(0)
s_add_u32 s40, s20, 1048576
s_addc_u32 s41, s21, 0
s_mov_b32 s42, 1056768
s_mov_b32 s43, 0x20000
s_lshl_b32 s64, s54, 8
s_load_dword s14, s[40:41], s64
s_lshl_b32 s47, s51, 17
s_add_u32 s32, s12, s47
s_addc_u32 s33, s13, 0
s_mov_b32 s34, 0x20000
s_mov_b32 s35, 0x20000
s_mov_b32 s36, s4
s_mov_b32 s37, s5
s_mov_b32 s38, 2048
s_mov_b32 s39, 0x20000
s_lshl_b32 s47, s51, 8
s_add_u32 s28, s10, s47
s_addc_u32 s29, s11, 0
s_sub_u32 s30, 0x400000, s47
s_mov_b32 s31, 0x20000
v_and_b32 v48, 2, v3
v_lshlrev_b32 v48, 1, v48
v_lshl_add_u32 v48, v2, 4, v48
s_lshl_b32 s47, s52, 10
s_lshl_b32 s64, s48, 8
s_add_u32 s47, s47, s64
buffer_load_dword v64, v48, s[36:39], s47 offen
buffer_load_dword v65, v48, s[36:39], s47 offen offset:8
v_lshlrev_b32 v49, 13, v3
v_lshl_add_u32 v49, v2, 4, v49
s_lshl_b32 s47, s48, 20
buffer_load_dwordx4 v[128:131], v49, s[28:31], s47 offen nt
s_add_u32 s47, s47, 32768
buffer_load_dwordx4 v[132:135], v49, s[28:31], s47 offen nt
s_add_u32 s47, s47, 32768
buffer_load_dwordx4 v[136:139], v49, s[28:31], s47 offen nt
s_add_u32 s47, s47, 32768
buffer_load_dwordx4 v[140:143], v49, s[28:31], s47 offen nt
s_add_u32 s47, s47, 32768
buffer_load_dwordx4 v[144:147], v49, s[28:31], s47 offen nt
s_add_u32 s47, s47, 32768
buffer_load_dwordx4 v[148:151], v49, s[28:31], s47 offen nt
s_add_u32 s47, s47, 32768
buffer_load_dwordx4 v[152:155], v49, s[28:31], s47 offen nt
s_add_u32 s47, s47, 32768
buffer_load_dwordx4 v[156:159], v49, s[28:31], s47 offen nt
s_add_u32 s47, s47, 32768
buffer_load_dwordx4 v[160:163], v49, s[28:31], s47 offen nt
s_add_u32 s47, s47, 32768
buffer_load_dwordx4 v[164:167], v49, s[28:31], s47 offen nt
s_add_u32 s47, s47, 32768
buffer_load_dwordx4 v[168:171], v49, s[28:31], s47 offen nt
s_add_u32 s47, s47, 32768
buffer_load_dwordx4 v[172:175], v49, s[28:31], s47 offen nt
s_add_u32 s47, s47, 32768
buffer_load_dwordx4 v[176:179], v49, s[28:31], s47 offen nt
s_add_u32 s47, s47, 32768
buffer_load_dwordx4 v[180:183], v49, s[28:31], s47 offen nt
s_add_u32 s47, s47, 32768
buffer_load_dwordx4 v[184:187], v49, s[28:31], s47 offen nt
s_add_u32 s47, s47, 32768
buffer_load_dwordx4 v[188:191], v49, s[28:31], s47 offen nt
s_add_u32 s47, s47, 32768
buffer_load_dwordx4 v[192:195], v49, s[28:31], s47 offen nt
s_add_u32 s47, s47, 32768
buffer_load_dwordx4 v[196:199], v49, s[28:31], s47 offen nt
s_add_u32 s47, s47, 32768
buffer_load_dwordx4 v[200:203], v49, s[28:31], s47 offen nt
s_add_u32 s47, s47, 32768
buffer_load_dwordx4 v[204:207], v49, s[28:31], s47 offen nt
s_add_u32 s47, s47, 32768
buffer_load_dwordx4 v[208:211], v49, s[28:31], s47 offen nt
s_add_u32 s47, s47, 32768
buffer_load_dwordx4 v[212:215], v49, s[28:31], s47 offen nt
s_add_u32 s47, s47, 32768
buffer_load_dwordx4 v[216:219], v49, s[28:31], s47 offen nt
s_add_u32 s47, s47, 32768
buffer_load_dwordx4 v[220:223], v49, s[28:31], s47 offen nt
s_add_u32 s47, s47, 32768
buffer_load_dwordx4 v[224:227], v49, s[28:31], s47 offen nt
s_add_u32 s47, s47, 32768
buffer_load_dwordx4 v[228:231], v49, s[28:31], s47 offen nt
s_add_u32 s47, s47, 32768
buffer_load_dwordx4 v[232:235], v49, s[28:31], s47 offen nt
s_add_u32 s47, s47, 32768
buffer_load_dwordx4 v[236:239], v49, s[28:31], s47 offen nt
s_add_u32 s47, s47, 32768
buffer_load_dwordx4 v[240:243], v49, s[28:31], s47 offen nt
s_add_u32 s47, s47, 32768
buffer_load_dwordx4 v[244:247], v49, s[28:31], s47 offen nt
s_add_u32 s47, s47, 32768
buffer_load_dwordx4 v[248:251], v49, s[28:31], s47 offen nt
s_add_u32 s47, s47, 32768
buffer_load_dwordx4 v[252:255], v49, s[28:31], s47 offen nt
v_and_b32 v66, 1, v3
v_mov_b32 v67, 0x01000100
v_mov_b32 v68, 0x03020302
v_cmp_eq_u32 vcc, 1, v66
s_nop 1
v_cndmask_b32 v66, v67, v68, vcc
s_cmp_eq_u32 s48, 0
s_cbranch_scc0 L_noclear
v_mov_b32 v52, -1
v_mov_b32 v53, -1
v_mov_b32 v54, -1
v_mov_b32 v55, -1
v_mov_b32 v56, 0
s_mov_b64 exec, 1
ds_write_b128 v56, v[52:55] offset:20480
ds_write_b128 v56, v[52:55] offset:20496
ds_write_b32 v56, v56 offset:20512
s_mov_b64 exec, -1
L_noclear:
v_mov_b32 v44, 0
v_mov_b32 v45, 0
v_mov_b32 v46, 0
v_mov_b32 v47, 0
s_mov_b32 s64, 0x01000100
s_mov_b32 s65, 0x03020302
s_waitcnt vmcnt(31)
v_perm_b32 v64, v64, v64, v66
v_perm_b32 v65, v65, v65, v66
s_nop 1
v_and_b32_dpp v36, v64, v8 row_newbcast:0 row_mask:0xf bank_mask:0xf
v_and_b32_dpp v37, v64, v9 row_newbcast:0 row_mask:0xf bank_mask:0xf
v_and_b32_dpp v38, v64, v10 row_newbcast:0 row_mask:0xf bank_mask:0xf
v_and_b32_dpp v39, v64, v11 row_newbcast:0 row_mask:0xf bank_mask:0xf
s_nop 1
v_mfma_f32_16x16x32_bf16 v[44:47], v[36:39], v[128:131], v[44:47]
s_waitcnt vmcnt(30)
v_and_b32_dpp v40, v65, v8 row_newbcast:0 row_mask:0xf bank_mask:0xf
v_and_b32_dpp v41, v65, v9 row_newbcast:0 row_mask:0xf bank_mask:0xf
v_and_b32_dpp v42, v65, v10 row_newbcast:0 row_mask:0xf bank_mask:0xf
v_and_b32_dpp v43, v65, v11 row_newbcast:0 row_mask:0xf bank_mask:0xf
s_nop 1
v_mfma_f32_16x16x32_bf16 v[44:47], v[40:43], v[132:135], v[44:47]
s_waitcnt vmcnt(29)
v_and_b32_dpp v36, v64, v8 row_newbcast:1 row_mask:0xf bank_mask:0xf
v_and_b32_dpp v37, v64, v9 row_newbcast:1 row_mask:0xf bank_mask:0xf
v_and_b32_dpp v38, v64, v10 row_newbcast:1 row_mask:0xf bank_mask:0xf
v_and_b32_dpp v39, v64, v11 row_newbcast:1 row_mask:0xf bank_mask:0xf
s_nop 1
v_mfma_f32_16x16x32_bf16 v[44:47], v[36:39], v[136:139], v[44:47]
s_waitcnt vmcnt(28)
v_and_b32_dpp v40, v65, v8 row_newbcast:1 row_mask:0xf bank_mask:0xf
v_and_b32_dpp v41, v65, v9 row_newbcast:1 row_mask:0xf bank_mask:0xf
v_and_b32_dpp v42, v65, v10 row_newbcast:1 row_mask:0xf bank_mask:0xf
v_and_b32_dpp v43, v65, v11 row_newbcast:1 row_mask:0xf bank_mask:0xf
s_nop 1
v_mfma_f32_16x16x32_bf16 v[44:47], v[40:43], v[140:143], v[44:47]
s_waitcnt vmcnt(27)
v_and_b32_dpp v36, v64, v8 row_newbcast:2 row_mask:0xf bank_mask:0xf
v_and_b32_dpp v37, v64, v9 row_newbcast:2 row_mask:0xf bank_mask:0xf
v_and_b32_dpp v38, v64, v10 row_newbcast:2 row_mask:0xf bank_mask:0xf
v_and_b32_dpp v39, v64, v11 row_newbcast:2 row_mask:0xf bank_mask:0xf
s_nop 1
v_mfma_f32_16x16x32_bf16 v[44:47], v[36:39], v[144:147], v[44:47]
s_waitcnt vmcnt(26)
v_and_b32_dpp v40, v65, v8 row_newbcast:2 row_mask:0xf bank_mask:0xf
v_and_b32_dpp v41, v65, v9 row_newbcast:2 row_mask:0xf bank_mask:0xf
v_and_b32_dpp v42, v65, v10 row_newbcast:2 row_mask:0xf bank_mask:0xf
v_and_b32_dpp v43, v65, v11 row_newbcast:2 row_mask:0xf bank_mask:0xf
s_nop 1
v_mfma_f32_16x16x32_bf16 v[44:47], v[40:43], v[148:151], v[44:47]
s_waitcnt vmcnt(25)
v_and_b32_dpp v36, v64, v8 row_newbcast:3 row_mask:0xf bank_mask:0xf
v_and_b32_dpp v37, v64, v9 row_newbcast:3 row_mask:0xf bank_mask:0xf
v_and_b32_dpp v38, v64, v10 row_newbcast:3 row_mask:0xf bank_mask:0xf
v_and_b32_dpp v39, v64, v11 row_newbcast:3 row_mask:0xf bank_mask:0xf
s_nop 1
v_mfma_f32_16x16x32_bf16 v[44:47], v[36:39], v[152:155], v[44:47]
s_waitcnt vmcnt(24)
v_and_b32_dpp v40, v65, v8 row_newbcast:3 row_mask:0xf bank_mask:0xf
v_and_b32_dpp v41, v65, v9 row_newbcast:3 row_mask:0xf bank_mask:0xf
v_and_b32_dpp v42, v65, v10 row_newbcast:3 row_mask:0xf bank_mask:0xf
v_and_b32_dpp v43, v65, v11 row_newbcast:3 row_mask:0xf bank_mask:0xf
s_nop 1
v_mfma_f32_16x16x32_bf16 v[44:47], v[40:43], v[156:159], v[44:47]
s_waitcnt vmcnt(23)
v_and_b32_dpp v36, v64, v8 row_newbcast:4 row_mask:0xf bank_mask:0xf
v_and_b32_dpp v37, v64, v9 row_newbcast:4 row_mask:0xf bank_mask:0xf
v_and_b32_dpp v38, v64, v10 row_newbcast:4 row_mask:0xf bank_mask:0xf
v_and_b32_dpp v39, v64, v11 row_newbcast:4 row_mask:0xf bank_mask:0xf
s_nop 1
v_mfma_f32_16x16x32_bf16 v[44:47], v[36:39], v[160:163], v[44:47]
s_waitcnt vmcnt(22)
v_and_b32_dpp v40, v65, v8 row_newbcast:4 row_mask:0xf bank_mask:0xf
v_and_b32_dpp v41, v65, v9 row_newbcast:4 row_mask:0xf bank_mask:0xf
v_and_b32_dpp v42, v65, v10 row_newbcast:4 row_mask:0xf bank_mask:0xf
v_and_b32_dpp v43, v65, v11 row_newbcast:4 row_mask:0xf bank_mask:0xf
s_nop 1
v_mfma_f32_16x16x32_bf16 v[44:47], v[40:43], v[164:167], v[44:47]
s_waitcnt vmcnt(21)
v_and_b32_dpp v36, v64, v8 row_newbcast:5 row_mask:0xf bank_mask:0xf
v_and_b32_dpp v37, v64, v9 row_newbcast:5 row_mask:0xf bank_mask:0xf
v_and_b32_dpp v38, v64, v10 row_newbcast:5 row_mask:0xf bank_mask:0xf
v_and_b32_dpp v39, v64, v11 row_newbcast:5 row_mask:0xf bank_mask:0xf
s_nop 1
v_mfma_f32_16x16x32_bf16 v[44:47], v[36:39], v[168:171], v[44:47]
s_waitcnt vmcnt(20)
v_and_b32_dpp v40, v65, v8 row_newbcast:5 row_mask:0xf bank_mask:0xf
v_and_b32_dpp v41, v65, v9 row_newbcast:5 row_mask:0xf bank_mask:0xf
v_and_b32_dpp v42, v65, v10 row_newbcast:5 row_mask:0xf bank_mask:0xf
v_and_b32_dpp v43, v65, v11 row_newbcast:5 row_mask:0xf bank_mask:0xf
s_nop 1
v_mfma_f32_16x16x32_bf16 v[44:47], v[40:43], v[172:175], v[44:47]
s_waitcnt vmcnt(19)
v_and_b32_dpp v36, v64, v8 row_newbcast:6 row_mask:0xf bank_mask:0xf
v_and_b32_dpp v37, v64, v9 row_newbcast:6 row_mask:0xf bank_mask:0xf
v_and_b32_dpp v38, v64, v10 row_newbcast:6 row_mask:0xf bank_mask:0xf
v_and_b32_dpp v39, v64, v11 row_newbcast:6 row_mask:0xf bank_mask:0xf
s_nop 1
v_mfma_f32_16x16x32_bf16 v[44:47], v[36:39], v[176:179], v[44:47]
s_waitcnt vmcnt(18)
v_and_b32_dpp v40, v65, v8 row_newbcast:6 row_mask:0xf bank_mask:0xf
v_and_b32_dpp v41, v65, v9 row_newbcast:6 row_mask:0xf bank_mask:0xf
v_and_b32_dpp v42, v65, v10 row_newbcast:6 row_mask:0xf bank_mask:0xf
v_and_b32_dpp v43, v65, v11 row_newbcast:6 row_mask:0xf bank_mask:0xf
s_nop 1
v_mfma_f32_16x16x32_bf16 v[44:47], v[40:43], v[180:183], v[44:47]
s_waitcnt vmcnt(17)
v_and_b32_dpp v36, v64, v8 row_newbcast:7 row_mask:0xf bank_mask:0xf
v_and_b32_dpp v37, v64, v9 row_newbcast:7 row_mask:0xf bank_mask:0xf
v_and_b32_dpp v38, v64, v10 row_newbcast:7 row_mask:0xf bank_mask:0xf
v_and_b32_dpp v39, v64, v11 row_newbcast:7 row_mask:0xf bank_mask:0xf
s_nop 1
v_mfma_f32_16x16x32_bf16 v[44:47], v[36:39], v[184:187], v[44:47]
s_waitcnt vmcnt(16)
v_and_b32_dpp v40, v65, v8 row_newbcast:7 row_mask:0xf bank_mask:0xf
v_and_b32_dpp v41, v65, v9 row_newbcast:7 row_mask:0xf bank_mask:0xf
v_and_b32_dpp v42, v65, v10 row_newbcast:7 row_mask:0xf bank_mask:0xf
v_and_b32_dpp v43, v65, v11 row_newbcast:7 row_mask:0xf bank_mask:0xf
s_nop 1
v_mfma_f32_16x16x32_bf16 v[44:47], v[40:43], v[188:191], v[44:47]
s_waitcnt vmcnt(15)
v_and_b32_dpp v36, v64, v8 row_newbcast:8 row_mask:0xf bank_mask:0xf
v_and_b32_dpp v37, v64, v9 row_newbcast:8 row_mask:0xf bank_mask:0xf
v_and_b32_dpp v38, v64, v10 row_newbcast:8 row_mask:0xf bank_mask:0xf
v_and_b32_dpp v39, v64, v11 row_newbcast:8 row_mask:0xf bank_mask:0xf
s_nop 1
v_mfma_f32_16x16x32_bf16 v[44:47], v[36:39], v[192:195], v[44:47]
s_waitcnt vmcnt(14)
v_and_b32_dpp v40, v65, v8 row_newbcast:8 row_mask:0xf bank_mask:0xf
v_and_b32_dpp v41, v65, v9 row_newbcast:8 row_mask:0xf bank_mask:0xf
v_and_b32_dpp v42, v65, v10 row_newbcast:8 row_mask:0xf bank_mask:0xf
v_and_b32_dpp v43, v65, v11 row_newbcast:8 row_mask:0xf bank_mask:0xf
s_nop 1
v_mfma_f32_16x16x32_bf16 v[44:47], v[40:43], v[196:199], v[44:47]
s_waitcnt vmcnt(13)
v_and_b32_dpp v36, v64, v8 row_newbcast:9 row_mask:0xf bank_mask:0xf
v_and_b32_dpp v37, v64, v9 row_newbcast:9 row_mask:0xf bank_mask:0xf
v_and_b32_dpp v38, v64, v10 row_newbcast:9 row_mask:0xf bank_mask:0xf
v_and_b32_dpp v39, v64, v11 row_newbcast:9 row_mask:0xf bank_mask:0xf
s_nop 1
v_mfma_f32_16x16x32_bf16 v[44:47], v[36:39], v[200:203], v[44:47]
s_waitcnt vmcnt(12)
v_and_b32_dpp v40, v65, v8 row_newbcast:9 row_mask:0xf bank_mask:0xf
v_and_b32_dpp v41, v65, v9 row_newbcast:9 row_mask:0xf bank_mask:0xf
v_and_b32_dpp v42, v65, v10 row_newbcast:9 row_mask:0xf bank_mask:0xf
v_and_b32_dpp v43, v65, v11 row_newbcast:9 row_mask:0xf bank_mask:0xf
s_nop 1
v_mfma_f32_16x16x32_bf16 v[44:47], v[40:43], v[204:207], v[44:47]
s_waitcnt vmcnt(11)
v_and_b32_dpp v36, v64, v8 row_newbcast:10 row_mask:0xf bank_mask:0xf
v_and_b32_dpp v37, v64, v9 row_newbcast:10 row_mask:0xf bank_mask:0xf
v_and_b32_dpp v38, v64, v10 row_newbcast:10 row_mask:0xf bank_mask:0xf
v_and_b32_dpp v39, v64, v11 row_newbcast:10 row_mask:0xf bank_mask:0xf
s_nop 1
v_mfma_f32_16x16x32_bf16 v[44:47], v[36:39], v[208:211], v[44:47]
s_waitcnt vmcnt(10)
v_and_b32_dpp v40, v65, v8 row_newbcast:10 row_mask:0xf bank_mask:0xf
v_and_b32_dpp v41, v65, v9 row_newbcast:10 row_mask:0xf bank_mask:0xf
v_and_b32_dpp v42, v65, v10 row_newbcast:10 row_mask:0xf bank_mask:0xf
v_and_b32_dpp v43, v65, v11 row_newbcast:10 row_mask:0xf bank_mask:0xf
s_nop 1
v_mfma_f32_16x16x32_bf16 v[44:47], v[40:43], v[212:215], v[44:47]
s_waitcnt vmcnt(9)
v_and_b32_dpp v36, v64, v8 row_newbcast:11 row_mask:0xf bank_mask:0xf
v_and_b32_dpp v37, v64, v9 row_newbcast:11 row_mask:0xf bank_mask:0xf
v_and_b32_dpp v38, v64, v10 row_newbcast:11 row_mask:0xf bank_mask:0xf
v_and_b32_dpp v39, v64, v11 row_newbcast:11 row_mask:0xf bank_mask:0xf
s_nop 1
v_mfma_f32_16x16x32_bf16 v[44:47], v[36:39], v[216:219], v[44:47]
s_waitcnt vmcnt(8)
v_and_b32_dpp v40, v65, v8 row_newbcast:11 row_mask:0xf bank_mask:0xf
v_and_b32_dpp v41, v65, v9 row_newbcast:11 row_mask:0xf bank_mask:0xf
v_and_b32_dpp v42, v65, v10 row_newbcast:11 row_mask:0xf bank_mask:0xf
v_and_b32_dpp v43, v65, v11 row_newbcast:11 row_mask:0xf bank_mask:0xf
s_nop 1
v_mfma_f32_16x16x32_bf16 v[44:47], v[40:43], v[220:223], v[44:47]
s_waitcnt vmcnt(7)
v_and_b32_dpp v36, v64, v8 row_newbcast:12 row_mask:0xf bank_mask:0xf
v_and_b32_dpp v37, v64, v9 row_newbcast:12 row_mask:0xf bank_mask:0xf
v_and_b32_dpp v38, v64, v10 row_newbcast:12 row_mask:0xf bank_mask:0xf
v_and_b32_dpp v39, v64, v11 row_newbcast:12 row_mask:0xf bank_mask:0xf
s_nop 1
v_mfma_f32_16x16x32_bf16 v[44:47], v[36:39], v[224:227], v[44:47]
s_waitcnt vmcnt(6)
v_and_b32_dpp v40, v65, v8 row_newbcast:12 row_mask:0xf bank_mask:0xf
v_and_b32_dpp v41, v65, v9 row_newbcast:12 row_mask:0xf bank_mask:0xf
v_and_b32_dpp v42, v65, v10 row_newbcast:12 row_mask:0xf bank_mask:0xf
v_and_b32_dpp v43, v65, v11 row_newbcast:12 row_mask:0xf bank_mask:0xf
s_nop 1
v_mfma_f32_16x16x32_bf16 v[44:47], v[40:43], v[228:231], v[44:47]
s_waitcnt vmcnt(5)
v_and_b32_dpp v36, v64, v8 row_newbcast:13 row_mask:0xf bank_mask:0xf
v_and_b32_dpp v37, v64, v9 row_newbcast:13 row_mask:0xf bank_mask:0xf
v_and_b32_dpp v38, v64, v10 row_newbcast:13 row_mask:0xf bank_mask:0xf
v_and_b32_dpp v39, v64, v11 row_newbcast:13 row_mask:0xf bank_mask:0xf
s_nop 1
v_mfma_f32_16x16x32_bf16 v[44:47], v[36:39], v[232:235], v[44:47]
s_waitcnt vmcnt(4)
v_and_b32_dpp v40, v65, v8 row_newbcast:13 row_mask:0xf bank_mask:0xf
v_and_b32_dpp v41, v65, v9 row_newbcast:13 row_mask:0xf bank_mask:0xf
v_and_b32_dpp v42, v65, v10 row_newbcast:13 row_mask:0xf bank_mask:0xf
v_and_b32_dpp v43, v65, v11 row_newbcast:13 row_mask:0xf bank_mask:0xf
s_nop 1
v_mfma_f32_16x16x32_bf16 v[44:47], v[40:43], v[236:239], v[44:47]
s_waitcnt vmcnt(3)
v_and_b32_dpp v36, v64, v8 row_newbcast:14 row_mask:0xf bank_mask:0xf
v_and_b32_dpp v37, v64, v9 row_newbcast:14 row_mask:0xf bank_mask:0xf
v_and_b32_dpp v38, v64, v10 row_newbcast:14 row_mask:0xf bank_mask:0xf
v_and_b32_dpp v39, v64, v11 row_newbcast:14 row_mask:0xf bank_mask:0xf
s_nop 1
v_mfma_f32_16x16x32_bf16 v[44:47], v[36:39], v[240:243], v[44:47]
s_waitcnt vmcnt(2)
v_and_b32_dpp v40, v65, v8 row_newbcast:14 row_mask:0xf bank_mask:0xf
v_and_b32_dpp v41, v65, v9 row_newbcast:14 row_mask:0xf bank_mask:0xf
v_and_b32_dpp v42, v65, v10 row_newbcast:14 row_mask:0xf bank_mask:0xf
v_and_b32_dpp v43, v65, v11 row_newbcast:14 row_mask:0xf bank_mask:0xf
s_nop 1
v_mfma_f32_16x16x32_bf16 v[44:47], v[40:43], v[244:247], v[44:47]
s_waitcnt vmcnt(1)
v_and_b32_dpp v36, v64, v8 row_newbcast:15 row_mask:0xf bank_mask:0xf
v_and_b32_dpp v37, v64, v9 row_newbcast:15 row_mask:0xf bank_mask:0xf
v_and_b32_dpp v38, v64, v10 row_newbcast:15 row_mask:0xf bank_mask:0xf
v_and_b32_dpp v39, v64, v11 row_newbcast:15 row_mask:0xf bank_mask:0xf
s_nop 1
v_mfma_f32_16x16x32_bf16 v[44:47], v[36:39], v[248:251], v[44:47]
s_waitcnt vmcnt(0)
v_and_b32_dpp v40, v65, v8 row_newbcast:15 row_mask:0xf bank_mask:0xf
v_and_b32_dpp v41, v65, v9 row_newbcast:15 row_mask:0xf bank_mask:0xf
v_and_b32_dpp v42, v65, v10 row_newbcast:15 row_mask:0xf bank_mask:0xf
v_and_b32_dpp v43, v65, v11 row_newbcast:15 row_mask:0xf bank_mask:0xf
s_nop 1
v_mfma_f32_16x16x32_bf16 v[44:47], v[40:43], v[252:255], v[44:47]
v_lshl_add_u32 v29, v5, 9, v7
s_nop 7
s_mov_b32 exec_hi, 0
ds_write_b128 v29, v[44:47] offset:16384
s_mov_b32 exec_hi, -1
s_waitcnt lgkmcnt(0)
L_h_bq:
s_barrier
s_mul_i32 s94, s14, 0x9e3779b1
s_add_u32 s94, s94, 0x85ebca6b
s_mul_i32 s95, s14, 0xc2b2ae35
s_add_u32 s95, s95, 0x27d4eb2f
s_mov_b32 s47, 0
buffer_load_dwordx4 v[128:131], v50, s[32:35], s47 offen offset:0 nt
s_waitcnt vmcnt(0)
buffer_load_dwordx4 v[132:135], v50, s[32:35], s47 offen offset:1024 nt
s_waitcnt vmcnt(0)
buffer_load_dwordx4 v[136:139], v50, s[32:35], s47 offen offset:2048 nt
s_waitcnt vmcnt(0)
buffer_load_dwordx4 v[140:143], v50, s[32:35], s47 offen offset:3072 nt
s_add_u32 s47, s47, 4096
s_waitcnt vmcnt(0)
buffer_load_dwordx4 v[144:147], v50, s[32:35], s47 offen offset:0 nt
s_waitcnt vmcnt(0)
buffer_load_dwordx4 v[148:151], v50, s[32:35], s47 offen offset:1024 nt
s_waitcnt vmcnt(0)
buffer_load_dwordx4 v[152:155], v50, s[32:35], s47 offen offset:2048 nt
s_waitcnt vmcnt(0)
buffer_load_dwordx4 v[156:159], v50, s[32:35], s47 offen offset:3072 nt
s_add_u32 s47, s47, 4096
s_waitcnt vmcnt(0)
buffer_load_dwordx4 v[160:163], v50, s[32:35], s47 offen offset:0 nt
s_waitcnt vmcnt(0)
buffer_load_dwordx4 v[164:167], v50, s[32:35], s47 offen offset:1024 nt
s_waitcnt vmcnt(0)
buffer_load_dwordx4 v[168:171], v50, s[32:35], s47 offen offset:2048 nt
s_waitcnt vmcnt(0)
buffer_load_dwordx4 v[172:175], v50, s[32:35], s47 offen offset:3072 nt
s_add_u32 s47, s47, 4096
s_waitcnt vmcnt(0)
buffer_load_dwordx4 v[176:179], v50, s[32:35], s47 offen offset:0 nt
s_waitcnt vmcnt(0)
buffer_load_dwordx4 v[180:183], v50, s[32:35], s47 offen offset:1024 nt
s_waitcnt vmcnt(0)
buffer_load_dwordx4 v[184:187], v50, s[32:35], s47 offen offset:2048 nt
s_waitcnt vmcnt(0)
buffer_load_dwordx4 v[188:191], v50, s[32:35], s47 offen offset:3072 nt
s_add_u32 s47, s47, 4096
s_waitcnt vmcnt(0)
buffer_load_dwordx4 v[192:195], v50, s[32:35], s47 offen offset:0 nt
s_waitcnt vmcnt(0)
buffer_load_dwordx4 v[196:199], v50, s[32:35], s47 offen offset:1024 nt
s_waitcnt vmcnt(0)
buffer_load_dwordx4 v[200:203], v50, s[32:35], s47 offen offset:2048 nt
s_waitcnt vmcnt(0)
buffer_load_dwordx4 v[204:207], v50, s[32:35], s47 offen offset:3072 nt
s_add_u32 s47, s47, 4096
s_waitcnt vmcnt(0)
buffer_load_dwordx4 v[208:211], v50, s[32:35], s47 offen offset:0 nt
s_waitcnt vmcnt(0)
buffer_load_dwordx4 v[212:215], v50, s[32:35], s47 offen offset:1024 nt
s_waitcnt vmcnt(0)
buffer_load_dwordx4 v[216:219], v50, s[32:35], s47 offen offset:2048 nt
s_waitcnt vmcnt(0)
buffer_load_dwordx4 v[220:223], v50, s[32:35], s47 offen offset:3072 nt
s_add_u32 s47, s47, 4096
s_waitcnt vmcnt(0)
buffer_load_dwordx4 v[224:227], v50, s[32:35], s47 offen offset:0 nt
s_waitcnt vmcnt(0)
buffer_load_dwordx4 v[228:231], v50, s[32:35], s47 offen offset:1024 nt
s_waitcnt vmcnt(0)
buffer_load_dwordx4 v[232:235], v50, s[32:35], s47 offen offset:2048 nt
s_waitcnt vmcnt(0)
buffer_load_dwordx4 v[236:239], v50, s[32:35], s47 offen offset:3072 nt
s_add_u32 s47, s47, 4096
s_waitcnt vmcnt(0)
buffer_load_dwordx4 v[240:243], v50, s[32:35], s47 offen offset:0 nt
s_waitcnt vmcnt(0)
buffer_load_dwordx4 v[244:247], v50, s[32:35], s47 offen offset:1024 nt
s_waitcnt vmcnt(0)
buffer_load_dwordx4 v[248:251], v50, s[32:35], s47 offen offset:2048 nt
s_waitcnt vmcnt(0)
buffer_load_dwordx4 v[252:255], v50, s[32:35], s47 offen offset:3072 nt
s_cmp_eq_u32 s48, 3
s_cbranch_scc0 L_h_wait
v_mov_b32 v29, 0
s_mov_b32 s67, 0
L_mlh:
s_sleep 32
ds_read_b128 v[64:67], v29 offset:20480
ds_read_b128 v[68:71], v29 offset:20496
s_waitcnt lgkmcnt(0)
v_max3_u32 v30, v64, v65, v66
v_max3_u32 v30, v30, v67, v68
v_max3_u32 v30, v30, v69, v70
v_max_u32 v30, v30, v71
v_cmp_eq_u32 vcc, -1, v30
s_add_u32 s67, s67, 1
s_cmp_ge_u32 s67, 100000
s_cbranch_scc1 L_mlh_go
s_cbranch_vccnz L_mlh
L_mlh_go:
v_max3_f32 v30, v64, v65, v66
v_max_f32 v30, v30, v67
v_sub_f32 v64, v64, v30
v_sub_f32 v65, v65, v30
v_sub_f32 v66, v66, v30
v_sub_f32 v67, v67, v30
v_exp_f32 v64, v64
v_exp_f32 v65, v65
v_exp_f32 v66, v66
v_exp_f32 v67, v67
s_nop 0
v_mul_f32 v74, v64, v68
v_fmac_f32 v74, v65, v69
v_fmac_f32 v74, v66, v70
v_fmac_f32 v74, v67, v71
v_mov_b32 v72, v30
v_mov_b32 v73, s94
v_mov_b32 v75, s95
v_mov_b32 v76, 0
s_lshl_b32 s47, s66, 4
s_add_u32 s47, s47, 4096
s_mov_b64 exec, 1
buffer_store_dwordx4 v[72:75], v76, s[40:43], s47 offen sc1
s_mov_b64 exec, -1
L_h_wait:
s_waitcnt vmcnt(0)
v_lshlrev_b32 v48, 7, v3
v_lshl_add_u32 v48, v2, 3, v48
v_lshlrev_b32 v49, 10, v5
v_lshl_add_u32 v49, v2, 6, v49
v_lshl_add_u32 v49, v3, 5, v49
v_mov_b32 v112, 0
v_mov_b32 v113, 0
v_mov_b32 v114, 0
v_mov_b32 v115, 0
v_mov_b32 v53, s94
v_mov_b32 v55, s95
v_mov_b32 v57, s94
v_mov_b32 v59, s95
s_lshl_b32 s65, s66, 12
s_add_u32 s65, s65, 8192
s_barrier
ds_read_b64 v[80:81], v48 offset:18432
ds_read_b64 v[82:83], v48 offset:18944
ds_read_b64 v[84:85], v48 offset:19456
ds_read_b64 v[86:87], v48 offset:19968
s_waitcnt lgkmcnt(0)
v_add_f32 v80, v80, v82
v_add_f32 v81, v81, v83
v_add_f32 v84, v84, v86
v_add_f32 v85, v85, v87
v_add_f32 v80, v80, v84
v_add_f32 v81, v81, v85
v_cvt_pk_bf16_f32 v88, v80, v80
v_cvt_pk_bf16_f32 v89, v81, v81
s_nop 1
v_and_b32_dpp v36, v88, v8 row_newbcast:0 row_mask:0xf bank_mask:0xf
v_and_b32_dpp v37, v88, v9 row_newbcast:0 row_mask:0xf bank_mask:0xf
v_and_b32_dpp v38, v88, v10 row_newbcast:0 row_mask:0xf bank_mask:0xf
v_and_b32_dpp v39, v88, v11 row_newbcast:0 row_mask:0xf bank_mask:0xf
v_and_b32_dpp v40, v89, v8 row_newbcast:0 row_mask:0xf bank_mask:0xf
v_and_b32_dpp v41, v89, v9 row_newbcast:0 row_mask:0xf bank_mask:0xf
v_and_b32_dpp v42, v89, v10 row_newbcast:0 row_mask:0xf bank_mask:0xf
v_and_b32_dpp v43, v89, v11 row_newbcast:0 row_mask:0xf bank_mask:0xf
v_mfma_f32_16x16x32_bf16 v[112:115], v[36:39], v[128:131], v[112:115]
v_and_b32_dpp v36, v88, v8 row_newbcast:1 row_mask:0xf bank_mask:0xf
v_and_b32_dpp v37, v88, v9 row_newbcast:1 row_mask:0xf bank_mask:0xf
v_and_b32_dpp v38, v88, v10 row_newbcast:1 row_mask:0xf bank_mask:0xf
v_and_b32_dpp v39, v88, v11 row_newbcast:1 row_mask:0xf bank_mask:0xf
v_mfma_f32_16x16x32_bf16 v[112:115], v[40:43], v[132:135], v[112:115]
v_and_b32_dpp v40, v89, v8 row_newbcast:1 row_mask:0xf bank_mask:0xf
v_and_b32_dpp v41, v89, v9 row_newbcast:1 row_mask:0xf bank_mask:0xf
v_and_b32_dpp v42, v89, v10 row_newbcast:1 row_mask:0xf bank_mask:0xf
v_and_b32_dpp v43, v89, v11 row_newbcast:1 row_mask:0xf bank_mask:0xf
v_mfma_f32_16x16x32_bf16 v[112:115], v[36:39], v[136:139], v[112:115]
v_and_b32_dpp v36, v88, v8 row_newbcast:2 row_mask:0xf bank_mask:0xf
v_and_b32_dpp v37, v88, v9 row_newbcast:2 row_mask:0xf bank_mask:0xf
v_and_b32_dpp v38, v88, v10 row_newbcast:2 row_mask:0xf bank_mask:0xf
v_and_b32_dpp v39, v88, v11 row_newbcast:2 row_mask:0xf bank_mask:0xf
v_mfma_f32_16x16x32_bf16 v[112:115], v[40:43], v[140:143], v[112:115]
v_and_b32_dpp v40, v89, v8 row_newbcast:2 row_mask:0xf bank_mask:0xf
v_and_b32_dpp v41, v89, v9 row_newbcast:2 row_mask:0xf bank_mask:0xf
v_and_b32_dpp v42, v89, v10 row_newbcast:2 row_mask:0xf bank_mask:0xf
v_and_b32_dpp v43, v89, v11 row_newbcast:2 row_mask:0xf bank_mask:0xf
v_mfma_f32_16x16x32_bf16 v[112:115], v[36:39], v[144:147], v[112:115]
v_and_b32_dpp v36, v88, v8 row_newbcast:3 row_mask:0xf bank_mask:0xf
v_and_b32_dpp v37, v88, v9 row_newbcast:3 row_mask:0xf bank_mask:0xf
v_and_b32_dpp v38, v88, v10 row_newbcast:3 row_mask:0xf bank_mask:0xf
v_and_b32_dpp v39, v88, v11 row_newbcast:3 row_mask:0xf bank_mask:0xf
v_mfma_f32_16x16x32_bf16 v[112:115], v[40:43], v[148:151], v[112:115]
v_and_b32_dpp v40, v89, v8 row_newbcast:3 row_mask:0xf bank_mask:0xf
v_and_b32_dpp v41, v89, v9 row_newbcast:3 row_mask:0xf bank_mask:0xf
v_and_b32_dpp v42, v89, v10 row_newbcast:3 row_mask:0xf bank_mask:0xf
v_and_b32_dpp v43, v89, v11 row_newbcast:3 row_mask:0xf bank_mask:0xf
v_mfma_f32_16x16x32_bf16 v[112:115], v[36:39], v[152:155], v[112:115]
v_and_b32_dpp v36, v88, v8 row_newbcast:4 row_mask:0xf bank_mask:0xf
v_and_b32_dpp v37, v88, v9 row_newbcast:4 row_mask:0xf bank_mask:0xf
v_and_b32_dpp v38, v88, v10 row_newbcast:4 row_mask:0xf bank_mask:0xf
v_and_b32_dpp v39, v88, v11 row_newbcast:4 row_mask:0xf bank_mask:0xf
v_mfma_f32_16x16x32_bf16 v[112:115], v[40:43], v[156:159], v[112:115]
v_and_b32_dpp v40, v89, v8 row_newbcast:4 row_mask:0xf bank_mask:0xf
v_and_b32_dpp v41, v89, v9 row_newbcast:4 row_mask:0xf bank_mask:0xf
v_and_b32_dpp v42, v89, v10 row_newbcast:4 row_mask:0xf bank_mask:0xf
v_and_b32_dpp v43, v89, v11 row_newbcast:4 row_mask:0xf bank_mask:0xf
v_mfma_f32_16x16x32_bf16 v[112:115], v[36:39], v[160:163], v[112:115]
v_and_b32_dpp v36, v88, v8 row_newbcast:5 row_mask:0xf bank_mask:0xf
v_and_b32_dpp v37, v88, v9 row_newbcast:5 row_mask:0xf bank_mask:0xf
v_and_b32_dpp v38, v88, v10 row_newbcast:5 row_mask:0xf bank_mask:0xf
v_and_b32_dpp v39, v88, v11 row_newbcast:5 row_mask:0xf bank_mask:0xf
v_mfma_f32_16x16x32_bf16 v[112:115], v[40:43], v[164:167], v[112:115]
v_and_b32_dpp v40, v89, v8 row_newbcast:5 row_mask:0xf bank_mask:0xf
v_and_b32_dpp v41, v89, v9 row_newbcast:5 row_mask:0xf bank_mask:0xf
v_and_b32_dpp v42, v89, v10 row_newbcast:5 row_mask:0xf bank_mask:0xf
v_and_b32_dpp v43, v89, v11 row_newbcast:5 row_mask:0xf bank_mask:0xf
v_mfma_f32_16x16x32_bf16 v[112:115], v[36:39], v[168:171], v[112:115]
v_and_b32_dpp v36, v88, v8 row_newbcast:6 row_mask:0xf bank_mask:0xf
v_and_b32_dpp v37, v88, v9 row_newbcast:6 row_mask:0xf bank_mask:0xf
v_and_b32_dpp v38, v88, v10 row_newbcast:6 row_mask:0xf bank_mask:0xf
v_and_b32_dpp v39, v88, v11 row_newbcast:6 row_mask:0xf bank_mask:0xf
v_mfma_f32_16x16x32_bf16 v[112:115], v[40:43], v[172:175], v[112:115]
v_and_b32_dpp v40, v89, v8 row_newbcast:6 row_mask:0xf bank_mask:0xf
v_and_b32_dpp v41, v89, v9 row_newbcast:6 row_mask:0xf bank_mask:0xf
v_and_b32_dpp v42, v89, v10 row_newbcast:6 row_mask:0xf bank_mask:0xf
v_and_b32_dpp v43, v89, v11 row_newbcast:6 row_mask:0xf bank_mask:0xf
v_mfma_f32_16x16x32_bf16 v[112:115], v[36:39], v[176:179], v[112:115]
v_and_b32_dpp v36, v88, v8 row_newbcast:7 row_mask:0xf bank_mask:0xf
v_and_b32_dpp v37, v88, v9 row_newbcast:7 row_mask:0xf bank_mask:0xf
v_and_b32_dpp v38, v88, v10 row_newbcast:7 row_mask:0xf bank_mask:0xf
v_and_b32_dpp v39, v88, v11 row_newbcast:7 row_mask:0xf bank_mask:0xf
v_mfma_f32_16x16x32_bf16 v[112:115], v[40:43], v[180:183], v[112:115]
v_and_b32_dpp v40, v89, v8 row_newbcast:7 row_mask:0xf bank_mask:0xf
v_and_b32_dpp v41, v89, v9 row_newbcast:7 row_mask:0xf bank_mask:0xf
v_and_b32_dpp v42, v89, v10 row_newbcast:7 row_mask:0xf bank_mask:0xf
v_and_b32_dpp v43, v89, v11 row_newbcast:7 row_mask:0xf bank_mask:0xf
v_mfma_f32_16x16x32_bf16 v[112:115], v[36:39], v[184:187], v[112:115]
v_and_b32_dpp v36, v88, v8 row_newbcast:8 row_mask:0xf bank_mask:0xf
v_and_b32_dpp v37, v88, v9 row_newbcast:8 row_mask:0xf bank_mask:0xf
v_and_b32_dpp v38, v88, v10 row_newbcast:8 row_mask:0xf bank_mask:0xf
v_and_b32_dpp v39, v88, v11 row_newbcast:8 row_mask:0xf bank_mask:0xf
v_mfma_f32_16x16x32_bf16 v[112:115], v[40:43], v[188:191], v[112:115]
v_and_b32_dpp v40, v89, v8 row_newbcast:8 row_mask:0xf bank_mask:0xf
v_and_b32_dpp v41, v89, v9 row_newbcast:8 row_mask:0xf bank_mask:0xf
v_and_b32_dpp v42, v89, v10 row_newbcast:8 row_mask:0xf bank_mask:0xf
v_and_b32_dpp v43, v89, v11 row_newbcast:8 row_mask:0xf bank_mask:0xf
v_mfma_f32_16x16x32_bf16 v[112:115], v[36:39], v[192:195], v[112:115]
v_and_b32_dpp v36, v88, v8 row_newbcast:9 row_mask:0xf bank_mask:0xf
v_and_b32_dpp v37, v88, v9 row_newbcast:9 row_mask:0xf bank_mask:0xf
v_and_b32_dpp v38, v88, v10 row_newbcast:9 row_mask:0xf bank_mask:0xf
v_and_b32_dpp v39, v88, v11 row_newbcast:9 row_mask:0xf bank_mask:0xf
v_mfma_f32_16x16x32_bf16 v[112:115], v[40:43], v[196:199], v[112:115]
v_and_b32_dpp v40, v89, v8 row_newbcast:9 row_mask:0xf bank_mask:0xf
v_and_b32_dpp v41, v89, v9 row_newbcast:9 row_mask:0xf bank_mask:0xf
v_and_b32_dpp v42, v89, v10 row_newbcast:9 row_mask:0xf bank_mask:0xf
v_and_b32_dpp v43, v89, v11 row_newbcast:9 row_mask:0xf bank_mask:0xf
v_mfma_f32_16x16x32_bf16 v[112:115], v[36:39], v[200:203], v[112:115]
v_and_b32_dpp v36, v88, v8 row_newbcast:10 row_mask:0xf bank_mask:0xf
v_and_b32_dpp v37, v88, v9 row_newbcast:10 row_mask:0xf bank_mask:0xf
v_and_b32_dpp v38, v88, v10 row_newbcast:10 row_mask:0xf bank_mask:0xf
v_and_b32_dpp v39, v88, v11 row_newbcast:10 row_mask:0xf bank_mask:0xf
v_mfma_f32_16x16x32_bf16 v[112:115], v[40:43], v[204:207], v[112:115]
v_and_b32_dpp v40, v89, v8 row_newbcast:10 row_mask:0xf bank_mask:0xf
v_and_b32_dpp v41, v89, v9 row_newbcast:10 row_mask:0xf bank_mask:0xf
v_and_b32_dpp v42, v89, v10 row_newbcast:10 row_mask:0xf bank_mask:0xf
v_and_b32_dpp v43, v89, v11 row_newbcast:10 row_mask:0xf bank_mask:0xf
v_mfma_f32_16x16x32_bf16 v[112:115], v[36:39], v[208:211], v[112:115]
v_and_b32_dpp v36, v88, v8 row_newbcast:11 row_mask:0xf bank_mask:0xf
v_and_b32_dpp v37, v88, v9 row_newbcast:11 row_mask:0xf bank_mask:0xf
v_and_b32_dpp v38, v88, v10 row_newbcast:11 row_mask:0xf bank_mask:0xf
v_and_b32_dpp v39, v88, v11 row_newbcast:11 row_mask:0xf bank_mask:0xf
v_mfma_f32_16x16x32_bf16 v[112:115], v[40:43], v[212:215], v[112:115]
v_and_b32_dpp v40, v89, v8 row_newbcast:11 row_mask:0xf bank_mask:0xf
v_and_b32_dpp v41, v89, v9 row_newbcast:11 row_mask:0xf bank_mask:0xf
v_and_b32_dpp v42, v89, v10 row_newbcast:11 row_mask:0xf bank_mask:0xf
v_and_b32_dpp v43, v89, v11 row_newbcast:11 row_mask:0xf bank_mask:0xf
v_mfma_f32_16x16x32_bf16 v[112:115], v[36:39], v[216:219], v[112:115]
v_and_b32_dpp v36, v88, v8 row_newbcast:12 row_mask:0xf bank_mask:0xf
v_and_b32_dpp v37, v88, v9 row_newbcast:12 row_mask:0xf bank_mask:0xf
v_and_b32_dpp v38, v88, v10 row_newbcast:12 row_mask:0xf bank_mask:0xf
v_and_b32_dpp v39, v88, v11 row_newbcast:12 row_mask:0xf bank_mask:0xf
v_mfma_f32_16x16x32_bf16 v[112:115], v[40:43], v[220:223], v[112:115]
v_and_b32_dpp v40, v89, v8 row_newbcast:12 row_mask:0xf bank_mask:0xf
v_and_b32_dpp v41, v89, v9 row_newbcast:12 row_mask:0xf bank_mask:0xf
v_and_b32_dpp v42, v89, v10 row_newbcast:12 row_mask:0xf bank_mask:0xf
v_and_b32_dpp v43, v89, v11 row_newbcast:12 row_mask:0xf bank_mask:0xf
v_mfma_f32_16x16x32_bf16 v[112:115], v[36:39], v[224:227], v[112:115]
v_and_b32_dpp v36, v88, v8 row_newbcast:13 row_mask:0xf bank_mask:0xf
v_and_b32_dpp v37, v88, v9 row_newbcast:13 row_mask:0xf bank_mask:0xf
v_and_b32_dpp v38, v88, v10 row_newbcast:13 row_mask:0xf bank_mask:0xf
v_and_b32_dpp v39, v88, v11 row_newbcast:13 row_mask:0xf bank_mask:0xf
v_mfma_f32_16x16x32_bf16 v[112:115], v[40:43], v[228:231], v[112:115]
v_and_b32_dpp v40, v89, v8 row_newbcast:13 row_mask:0xf bank_mask:0xf
v_and_b32_dpp v41, v89, v9 row_newbcast:13 row_mask:0xf bank_mask:0xf
v_and_b32_dpp v42, v89, v10 row_newbcast:13 row_mask:0xf bank_mask:0xf
v_and_b32_dpp v43, v89, v11 row_newbcast:13 row_mask:0xf bank_mask:0xf
v_mfma_f32_16x16x32_bf16 v[112:115], v[36:39], v[232:235], v[112:115]
v_and_b32_dpp v36, v88, v8 row_newbcast:14 row_mask:0xf bank_mask:0xf
v_and_b32_dpp v37, v88, v9 row_newbcast:14 row_mask:0xf bank_mask:0xf
v_and_b32_dpp v38, v88, v10 row_newbcast:14 row_mask:0xf bank_mask:0xf
v_and_b32_dpp v39, v88, v11 row_newbcast:14 row_mask:0xf bank_mask:0xf
v_mfma_f32_16x16x32_bf16 v[112:115], v[40:43], v[236:239], v[112:115]
v_and_b32_dpp v40, v89, v8 row_newbcast:14 row_mask:0xf bank_mask:0xf
v_and_b32_dpp v41, v89, v9 row_newbcast:14 row_mask:0xf bank_mask:0xf
v_and_b32_dpp v42, v89, v10 row_newbcast:14 row_mask:0xf bank_mask:0xf
v_and_b32_dpp v43, v89, v11 row_newbcast:14 row_mask:0xf bank_mask:0xf
v_mfma_f32_16x16x32_bf16 v[112:115], v[36:39], v[240:243], v[112:115]
v_and_b32_dpp v36, v88, v8 row_newbcast:15 row_mask:0xf bank_mask:0xf
v_and_b32_dpp v37, v88, v9 row_newbcast:15 row_mask:0xf bank_mask:0xf
v_and_b32_dpp v38, v88, v10 row_newbcast:15 row_mask:0xf bank_mask:0xf
v_and_b32_dpp v39, v88, v11 row_newbcast:15 row_mask:0xf bank_mask:0xf
v_mfma_f32_16x16x32_bf16 v[112:115], v[40:43], v[244:247], v[112:115]
v_and_b32_dpp v40, v89, v8 row_newbcast:15 row_mask:0xf bank_mask:0xf
v_and_b32_dpp v41, v89, v9 row_newbcast:15 row_mask:0xf bank_mask:0xf
v_and_b32_dpp v42, v89, v10 row_newbcast:15 row_mask:0xf bank_mask:0xf
v_and_b32_dpp v43, v89, v11 row_newbcast:15 row_mask:0xf bank_mask:0xf
v_mfma_f32_16x16x32_bf16 v[112:115], v[36:39], v[248:251], v[112:115]
s_nop 1
v_mfma_f32_16x16x32_bf16 v[112:115], v[40:43], v[252:255], v[112:115]
s_nop 7
v_mov_b32 v52, v112
v_mov_b32 v54, v113
v_mov_b32 v56, v114
v_mov_b32 v58, v115
s_mov_b32 exec_hi, 0
buffer_store_dwordx4 v[52:55], v49, s[40:43], s65 offen sc1
buffer_store_dwordx4 v[56:59], v49, s[40:43], s65 offen offset:16 sc1
s_mov_b32 exec_hi, -1
s_cmp_ge_u32 s48, 1
s_cbranch_scc1 L_h_tail
s_cmp_eq_u32 s48, 0
s_cbranch_scc0 L_end
v_lshrrev_b32 v29, 1, v1
v_and_b32 v30, 1, v1
v_lshlrev_b32 v60, 12, v29
v_lshl_add_u32 v60, v30, 5, v60
v_lshlrev_b32 v61, 4, v29
s_lshl_b32 s47, s54, 18
s_lshl_b32 s64, s55, 6
s_add_u32 s47, s47, s64
s_add_u32 s47, s47, 8192
s_add_u32 s64, s47, 0x20000
s_lshl_b32 s65, s54, 10
s_add_u32 s65, s65, 4096
s_mov_b32 s67, 0
L_poll:
buffer_load_dwordx4 v[80:83], v60, s[40:43], s47 offen sc1
buffer_load_dwordx4 v[84:87], v60, s[40:43], s47 offen offset:16 sc1
buffer_load_dwordx4 v[88:91], v60, s[40:43], s64 offen sc1
buffer_load_dwordx4 v[92:95], v60, s[40:43], s64 offen offset:16 sc1
buffer_load_dwordx4 v[96:99], v61, s[40:43], s65 offen sc1
buffer_load_dwordx4 v[100:103], v61, s[40:43], s65 offen offset:512 sc1
s_waitcnt vmcnt(0)
v_xor_b32 v30, s94, v81
v_xor_b32 v29, s95, v83
v_or_b32 v29, v29, v30
v_xor_b32 v30, s94, v85
v_or_b32 v29, v29, v30
v_xor_b32 v30, s95, v87
v_or_b32 v29, v29, v30
v_xor_b32 v30, s94, v89
v_or_b32 v29, v29, v30
v_xor_b32 v30, s95, v91
v_or_b32 v29, v29, v30
v_xor_b32 v30, s94, v93
v_or_b32 v29, v29, v30
v_xor_b32 v30, s95, v95
v_or_b32 v29, v29, v30
v_xor_b32 v30, s94, v97
v_or_b32 v29, v29, v30
v_xor_b32 v30, s95, v99
v_or_b32 v29, v29, v30
v_xor_b32 v30, s94, v101
v_or_b32 v29, v29, v30
v_xor_b32 v30, s95, v103
v_or_b32 v29, v29, v30
v_cmp_ne_u32 vcc, 0, v29
s_nop 1
s_cbranch_vccz L_poll_done
s_add_u32 s67, s67, 1
s_cmp_ge_u32 s67, 100000
s_cbranch_scc1 L_poll_done
s_mov_b64 exec, vcc
s_sleep 4
s_branch L_poll
L_poll_done:
s_mov_b64 exec, -1
v_mov_b32 v48, v80
v_mov_b32 v49, v82
v_mov_b32 v50, v84
v_mov_b32 v51, v86
v_mov_b32 v52, v88
v_mov_b32 v53, v90
v_mov_b32 v54, v92
v_mov_b32 v55, v94
v_mov_b32 v56, v96
v_mov_b32 v57, v98
v_mov_b32 v58, v100
v_mov_b32 v59, v102
s_nop 1
v_max_f32_dpp v64, v56, v56 quad_perm:[2,3,0,1] row_mask:0xf bank_mask:0xf
v_sub_f32 v64, v56, v64
v_exp_f32 v62, v64
s_nop 0
v_mul_f32 v65, v57, v62
s_nop 1
v_add_f32_dpp v65, v65, v65 quad_perm:[2,3,0,1] row_mask:0xf bank_mask:0xf
v_rcp_f32 v65, v65
s_nop 0
v_mul_f32 v62, v62, v65
v_max_f32_dpp v66, v58, v58 quad_perm:[2,3,0,1] row_mask:0xf bank_mask:0xf
v_sub_f32 v66, v58, v66
v_exp_f32 v63, v66
s_nop 0
v_mul_f32 v67, v59, v63
s_nop 1
v_add_f32_dpp v67, v67, v67 quad_perm:[2,3,0,1] row_mask:0xf bank_mask:0xf
v_rcp_f32 v67, v67
s_nop 0
v_mul_f32 v63, v63, v67
v_mul_f32 v48, v48, v62
v_mul_f32 v49, v49, v62
v_mul_f32 v50, v50, v62
v_mul_f32 v51, v51, v62
v_fmac_f32 v48, v52, v63
v_fmac_f32 v49, v53, v63
v_fmac_f32 v50, v54, v63
v_fmac_f32 v51, v55, v63
s_nop 1
v_add_f32_dpp v48, v48, v48 quad_perm:[2,3,0,1] row_mask:0xf bank_mask:0xf
v_add_f32_dpp v49, v49, v49 quad_perm:[2,3,0,1] row_mask:0xf bank_mask:0xf
v_add_f32_dpp v50, v50, v50 quad_perm:[2,3,0,1] row_mask:0xf bank_mask:0xf
v_add_f32_dpp v51, v51, v51 quad_perm:[2,3,0,1] row_mask:0xf bank_mask:0xf
v_add_f32_dpp v48, v48, v48 row_ror:4 row_mask:0xf bank_mask:0xf
v_add_f32_dpp v49, v49, v49 row_ror:4 row_mask:0xf bank_mask:0xf
v_add_f32_dpp v50, v50, v50 row_ror:4 row_mask:0xf bank_mask:0xf
v_add_f32_dpp v51, v51, v51 row_ror:4 row_mask:0xf bank_mask:0xf
v_add_f32_dpp v48, v48, v48 row_ror:8 row_mask:0xf bank_mask:0xf
v_add_f32_dpp v49, v49, v49 row_ror:8 row_mask:0xf bank_mask:0xf
v_add_f32_dpp v50, v50, v50 row_ror:8 row_mask:0xf bank_mask:0xf
v_add_f32_dpp v51, v51, v51 row_ror:8 row_mask:0xf bank_mask:0xf
v_mov_b32 v52, v48
v_mov_b32 v53, v49
v_mov_b32 v54, v50
v_mov_b32 v55, v51
s_nop 1
v_permlane16_swap_b32 v48, v52
v_permlane16_swap_b32 v49, v53
v_permlane16_swap_b32 v50, v54
v_permlane16_swap_b32 v51, v55
s_nop 1
v_add_f32 v48, v48, v52
v_add_f32 v49, v49, v53
v_add_f32 v50, v50, v54
v_add_f32 v51, v51, v55
v_mov_b32 v52, v48
v_mov_b32 v53, v49
v_mov_b32 v54, v50
v_mov_b32 v55, v51
s_nop 1
v_permlane32_swap_b32 v48, v52
v_permlane32_swap_b32 v49, v53
v_permlane32_swap_b32 v50, v54
v_permlane32_swap_b32 v51, v55
s_nop 1
v_add_f32 v48, v48, v52
v_add_f32 v49, v49, v53
v_add_f32 v50, v50, v54
v_add_f32 v51, v51, v55
v_cvt_pk_bf16_f32 v52, v48, v49
v_cvt_pk_bf16_f32 v53, v50, v51
s_lshl_b32 s47, s52, 11
s_lshl_b32 s64, s50, 10
s_add_u32 s47, s47, s64
s_lshl_b32 s64, s55, 4
s_add_u32 s47, s47, s64
v_lshlrev_b32 v29, 3, v1
v_add_u32 v29, s47, v29
s_mov_b64 exec, 3
global_store_dwordx2 v29, v[52:53], s[16:17]
s_mov_b64 exec, -1
s_cmp_eq_u32 s55, 0
s_cbranch_scc0 L_noe
s_add_u32 s47, s14, 1
s_lshl_b32 s64, s54, 8
v_mov_b32 v30, s47
v_mov_b32 v29, s64
s_mov_b64 exec, 1
buffer_store_dword v30, v29, s[40:43], 0 offen sc1
s_mov_b64 exec, -1
L_noe:
s_endpgm
L_h_tail:
L_end:
s_endpgm
.section .rodata,"a"
.p2align 6
.amdhsa_kernel concat_heads__gqa_block_cached__gqa_block_cached__decode_kernel
  .amdhsa_next_free_vgpr 256
  .amdhsa_next_free_sgpr 96
  .amdhsa_accum_offset 256
  .amdhsa_group_segment_fixed_size 0
  .amdhsa_kernarg_size 104
  .amdhsa_user_sgpr_count 2
  .amdhsa_user_sgpr_kernarg_segment_ptr 1
  .amdhsa_system_sgpr_workgroup_id_x 1
  .amdhsa_float_denorm_mode_32 3
.end_amdhsa_kernel
```
